```python
import torch

def _softmax(x, axis=-1):
    return torch.softmax(x, dim=axis)
def _gelu(x):
    return torch.nn.functional.gelu(x, approximate="tanh")
def _silu(x):
    return torch.nn.functional.silu(x)
def _sigmoid(x):
    return torch.sigmoid(x)
def _layernorm(x, axis=-1, eps=1e-5):
    m = x.mean(dim=axis, keepdim=True)
    v = x.var(dim=axis, keepdim=True, unbiased=False)
    return (x - m) / torch.sqrt(v + eps)
def _scatter_add(tgt, idx, src, axis=0):
    return tgt.clone().index_add_(axis, idx, src)
def _segment_sum(src, seg, n):
    out = torch.zeros((n,) + src.shape[1:], dtype=src.dtype)
    return out.index_add_(0, seg, src)
def _pad(x, pw):
    flat = tuple(v for pair in reversed(pw) for v in pair)
    return torch.nn.functional.pad(x, flat)

kernel_name = 'recurrent_scan__linear_attn_block__dense_activation_mish__prompt'

def setup_inputs():

    _w = (lambda a: (lambda t: t.to(torch.bfloat16) if t.is_floating_point() else t)(torch.as_tensor(a)))
    def _A_setup():
        B, S, D = 1, 2048, 448
        return {
            "x": _w((lambda *s: torch.randn(*s, dtype=torch.bfloat16) * 0.05)(B, S, D)),
            "wqkv": _w((lambda *s: torch.randn(*s, dtype=torch.bfloat16) * 0.2)(D, 3 * D)),
            "wo": _w((lambda *s: torch.randn(*s, dtype=torch.bfloat16) * 0.2)(D, D)),
        }
    _A_in = _A_setup()

    def _B_setup():
        B, S, D, F = 1, 2048, 448, 1792
        return {
            "x": _w((lambda *s: torch.randn(*s, dtype=torch.bfloat16) * 0.05)(B, S, D)),
            "w1": _w((lambda *s: torch.randn(*s, dtype=torch.bfloat16) * 0.8)(D, F) * (D ** -0.5)),
            "b1": _w((lambda *s: torch.randn(*s, dtype=torch.bfloat16) * 0.2)(F)),
            "w2": _w((lambda *s: torch.randn(*s, dtype=torch.bfloat16) * 0.1)(F, D) * (F ** -0.5)),
        }
    _B_in = _B_setup()

    return {
        "A_x": _A_in["x"],
        "A_wqkv": _A_in["wqkv"],
        "A_wo": _A_in["wo"],
        "B_x": _B_in["x"],
        "B_w1": _B_in["w1"],
        "B_b1": _B_in["b1"],
        "B_w2": _B_in["w2"],
    }

def reference(A_x, A_wqkv, A_wo, B_x, B_w1, B_b1, B_w2):
    def _A_ref(x, wqkv, wo):
        B, S, D = x.shape
        H = 16; Dh = D // H
        qkv = (lambda x, *d: x.permute(*d))((x @ wqkv).reshape(B, S, 3, H, Dh), 2, 0, 3, 1, 4)
        q, k, v = qkv[0], qkv[1], qkv[2]
        phi = lambda t: torch.where(t > 0, t + 1, torch.exp(t)) + 1e-6
        pq, pk = phi(q), phi(k)
        kv = torch.einsum("bhsd,bhse->bhde", pk, v)
        z = torch.einsum("bhsd->bhd", pk)
        num = torch.einsum("bhqd,bhde->bhqe", pq, kv)
        den = torch.einsum("bhqd,bhd->bhq", pq, z)[..., None] + 1e-6
        o = num / den
        return (lambda x, *d: x.permute(*d))(o, 0, 2, 1, 3).reshape(B, S, D) @ wo

    def _B_ref(x, w1, b1, w2):
        h = torch.einsum("bsd,df->bsf", x, w1) + b1
        sp = torch.log1p(torch.exp(-torch.abs(h))) + torch.where(h > 0, h, torch.zeros_like(h))
        act = h * torch.tanh(sp)
        return torch.einsum("bsf,fd->bsd", act, w2)

    x = A_x
    xn = _layernorm(x, axis=-1)
    s = _A_ref(xn, A_wqkv, A_wo)
    g = _silu(_B_ref(xn, B_w1, B_b1, B_w2))
    return x + s * g
```

```asm
; @launch grid=(256,1,1) block=(256,1,1) lds=163840
.amdgcn_target "amdgcn-amd-amdhsa--gfx950"
.text
.globl recurrent_scan__linear_attn_block__dense_activation_mish__prompt_kernel
.p2align 8
.type recurrent_scan__linear_attn_block__dense_activation_mish__prompt_kernel,@function
recurrent_scan__linear_attn_block__dense_activation_mish__prompt_kernel:
    s_cmp_ge_u32 s2, 256
    s_cbranch_scc1 L_end
    s_load_dwordx8 s[8:15], s[0:1], 0
    s_load_dwordx8 s[16:23], s[0:1], 32
    s_load_dwordx4 s[24:27], s[0:1], 64
    s_getpc_b64 s[34:35]
L_pc:
    v_lshlrev_b32 v19, 7, v0
    v_add_u32 v19, L_end-L_pc-32768, v19
    global_load_dword v254, v19, s[34:35]
    s_memrealtime s[66:67]
    v_lshrrev_b32 v4, 6, v0
    v_and_b32 v1, 63, v0
    v_readfirstlane_b32 s70, v4
    s_bfe_u32 s87, s2, 0x10002
    s_bfe_u32 s89, s2, 0x30003
    s_lshl3_add_u32 s68, s87, s89
    s_and_b32 s71, s2, 3
    s_lshr_b32 s90, s2, 6
    s_lshr_b32 s72, s68, 1
    s_lshl1_add_u32 s72, s71, s72
    s_and_b32 s87, s90, 1
    s_add_u32 s72, s72, s87
    s_sub_u32 s87, s72, 7
    s_min_u32 s72, s72, s87
    s_sub_u32 s87, s72, 7
    s_min_u32 s72, s72, s87
    s_and_b32 s83, s68, 1
    s_lshl_b32 s89, s83, 2
    v_lshrrev_b32 v5, 3, v1
    v_mul_u32_u24 v6, 896, v5
    v_lshrrev_b32 v7, 4, v1
    v_and_b32 v4, 7, v1
    v_xor_b32 v7, v4, v7
    v_xor_b32 v7, s89, v7
    v_lshl_add_u32 v16, v7, 4, v6
    v_xor_b32 v7, 4, v7
    v_lshl_add_u32 v17, v7, 4, v6
    v_add_u32 v17, 6144, v17
    v_add_u32 v252, 12288, v16
    v_add_u32 v253, 12288, v17
    s_lshl2_add_u32 s43, s68, s70
    s_mul_i32 s43, s43, 28672
    s_lshl_b32 s73, s72, 7
    s_add_u32 s73, s73, s43
    s_lshl_b32 s6, s70, 12
    s_mov_b32 m0, s6
    s_mov_b32 s30, 1835008
    s_mov_b32 s31, 0x20000
    s_waitcnt lgkmcnt(0)
    s_xor_b32 s87, s2, 195
    s_or_b32 s87, s87, s70
    s_cbranch_scc0 L_tag
L_tagr:
    s_mov_b64 s[28:29], s[8:9]
    buffer_load_dwordx4 v16, s[28:31], s73 offen offset:0 lds
    buffer_load_dwordx4 v17, s[28:31], s73 offen offset:1024 lds
    buffer_load_dwordx4 v252, s[28:31], s73 offen offset:2048 lds
    buffer_load_dwordx4 v253, s[28:31], s73 offen offset:3072 lds
    s_lshl2_add_u32 s69, s71, s90
    s_lshl4_add_u32 s86, s68, s69
    s_lshl2_add_u32 s86, s86, s70
    s_lshl_b32 s86, s86, 1
    v_and_b32 v6, 31, v1
    v_lshrrev_b32 v7, 5, v1
    v_mul_u32_u24 v7, 896, v7
    v_lshl_add_u32 v7, v6, 4, v7
    v_cmp_gt_u32 vcc, 28, v6
    v_mov_b32 v18, 1073741824
    s_mul_i32 s89, s86, 896
    v_cndmask_b32 v18, v18, v7, vcc
    buffer_load_dwordx4 v[8:11], v18, s[28:31], s89 offen
    buffer_load_dwordx4 v[12:15], v18, s[28:31], s89 offen offset:448
    s_lshl_b32 s83, s83, 1
    s_xor_b32 s91, s70, s83
    s_cmp_eq_u32 s90, 0
    s_cbranch_scc1 L_kvpro
    s_mul_i32 s71, s71, 3
    s_add_u32 s71, s71, s90
    s_sub_u32 s71, s71, 1
    s_lshl_b32 s87, s91, 4
    v_add_u32 v5, s87, v5
    v_bfe_u32 v6, v1, 4, 1
    v_lshlrev_b32 v6, 2, v6
    v_xor_b32 v6, v6, v4
    v_lshlrev_b32 v6, 4, v6
    s_mul_i32 s87, s71, 43
    s_lshr_b32 s87, s87, 7
    s_lshl_b32 s40, s71, 1
    s_add_u32 s40, s40, s87
    s_mul_i32 s7, s70, 6144
    s_lshl_b32 s87, s40, 7
    s_add_u32 s87, s87, 2048
    v_mul_u32_u24 v20, 3584, v5
    v_add3_u32 v20, v20, v6, s87
    v_add_u32 v21, 27648, v20
    v_subrev_u32 v22, 1920, v20
    v_subrev_u32 v23, 1920, v21
    s_mul_i32 s87, s71, 7
    s_sub_u32 s87, s87, 43
    s_cmp_lt_u32 s71, 7
    s_mov_b32 s88, 3584
    s_cselect_b32 s88, 2688, s88
    s_cselect_b32 s80, 0, 1
    s_cselect_b32 s87, s71, s87
    s_cselect_b32 s42, 0, 7
    s_add_u32 s42, s42, s87
    s_mul_i32 s38, s88, 448
    s_mov_b32 s39, 0x20000
    s_lshl_b32 s81, s88, 6
    s_lshl_b32 s82, s87, 7
    v_mul_u32_u24 v24, s88, v5
    v_add3_u32 v24, v24, v6, s82
    s_lshl_b32 s88, s88, 3
    s_sub_u32 s88, s88, 1024
    v_add_u32 v25, s88, v24
    s_cmp_eq_u32 s71, 11
    s_cselect_b32 s80, 2, s80
    s_cselect_b32 s38, 0, s38
    s_mul_i32 s74, s72, 229376
    s_mul_i32 s75, s72, s81
    s_add_u32 s72, s72, 1
    s_cmp_eq_u32 s72, 7
    s_cselect_b32 s72, 0, s72
    s_sub_u32 s32, s16, 2048
    s_subb_u32 s33, s17, 0
    s_mov_b32 s34, 1607680
    s_mov_b32 s35, 0x20000
    s_cmp_eq_u32 s80, 0
    s_cselect_b32 s36, s10, s16
    s_cselect_b32 s37, s11, s17
    s_add_u32 m0, s7, 49152
    s_nop 0
    buffer_load_dwordx4 v20, s[32:35], s74 offen offset:0 lds
    buffer_load_dwordx4 v21, s[32:35], s74 offen offset:1024 lds
    buffer_load_dwordx4 v22, s[32:35], s74 offen offset:2048 lds
    buffer_load_dwordx4 v23, s[32:35], s74 offen offset:3072 lds
    s_add_u32 m0, s7, 53248
    s_nop 0
    buffer_load_dwordx4 v24, s[36:39], s75 offen offset:0 lds
    buffer_load_dwordx4 v25, s[36:39], s75 offen offset:1024 lds
    s_mov_b32 s60, s18
    s_mov_b32 s61, s19
    s_mov_b32 s62, 3584
    s_mov_b32 s63, 0x20000
    v_lshrrev_b32 v5, 5, v0
    v_add_u32 v6, s40, v5
    v_lshlrev_b32 v6, 7, v6
    v_cmp_eq_u32 vcc, 2, v5
    v_mov_b32 v7, s82
    v_and_b32 v4, 31, v0
    v_cndmask_b32 v6, v6, v7, vcc
    v_lshl_add_u32 v4, v4, 2, v6
    buffer_load_dword v19, v4, s[60:63], 0 offen
    s_mul_i32 s87, s68, 140
    s_add_u32 s42, s42, s87
    s_lshl_b32 s42, s42, 12
    s_add_u32 s87, s87, s40
    s_add_u32 s87, s87, 7
    s_lshl_b32 s40, s87, 12
    s_add_u32 s41, s40, 4096
    s_mov_b32 s64, 0
    s_branch L_common
L_tag:
    s_mov_b32 s48, s24
    s_mov_b32 s49, s25
    s_mov_b32 s50, 256
    s_mov_b32 s51, 0x20000
    s_or_b32 s32, s66, 1
    v_mov_b32 v40, s32
    s_mov_b64 exec, 1
    buffer_store_dword v40, off, s[48:51], 0 sc1
    s_mov_b64 exec, -1
    s_branch L_tagr
L_kvpro:
    s_lshl_b32 s7, s70, 13
    s_mul_i32 s87, s71, 224
    s_mul_i32 s88, s91, 43008
    s_add_u32 s87, s87, s88
    s_add_u32 s87, s87, 896
    v_lshrrev_b32 v5, 5, v1
    v_add_u32 v5, 0, v5
    v_lshlrev_b32 v4, 2, v5
    v_sub_u32 v4, v1, v4
    v_and_b32 v4, 31, v4
    v_mul_u32_u24 v5, 2688, v5
    v_lshl_add_u32 v5, v4, 4, v5
    v_add_u32 v5, s87, v5
    v_cmp_lt_u32 vcc, 13, v4
    v_add_u32 v6, 672, v5
    v_mov_b32 v7, 1073741824
    v_cndmask_b32 v5, v5, v6, vcc
    v_cmp_lt_u32 vcc, 27, v4
    s_nop 1
    v_cndmask_b32 v20, v5, v7, vcc
    v_add_u32 v22, 8704, v20
    v_lshrrev_b32 v5, 5, v1
    v_add_u32 v5, 2, v5
    v_lshlrev_b32 v4, 2, v5
    v_sub_u32 v4, v1, v4
    v_and_b32 v4, 31, v4
    v_mul_u32_u24 v5, 2688, v5
    v_lshl_add_u32 v5, v4, 4, v5
    v_add_u32 v5, s87, v5
    v_cmp_lt_u32 vcc, 13, v4
    v_add_u32 v6, 672, v5
    v_mov_b32 v7, 1073741824
    v_cndmask_b32 v5, v5, v6, vcc
    v_cmp_lt_u32 vcc, 27, v4
    v_subrev_u32 v5, 1024, v5
    s_nop 0
    v_cndmask_b32 v21, v5, v7, vcc
    v_add_u32 v23, 8704, v21
    s_mul_i32 s74, s72, 172032
    s_add_u32 s75, s74, 21504
    s_add_u32 s72, s72, 1
    s_cmp_eq_u32 s72, 7
    s_cselect_b32 s72, 0, s72
    s_mov_b32 s32, s10
    s_mov_b32 s33, s11
    s_mov_b32 s34, 1204224
    s_mov_b32 s35, 0x20000
    s_add_u32 m0, s7, 49152
    s_nop 0
    buffer_load_dwordx4 v20, s[32:35], s74 offen offset:0 lds
    buffer_load_dwordx4 v21, s[32:35], s74 offen offset:1024 lds
    buffer_load_dwordx4 v22, s[32:35], s74 offen offset:2048 lds
    buffer_load_dwordx4 v23, s[32:35], s74 offen offset:3072 lds
    s_add_u32 m0, s7, 53248
    s_nop 0
    buffer_load_dwordx4 v20, s[32:35], s75 offen offset:0 lds
    buffer_load_dwordx4 v21, s[32:35], s75 offen offset:1024 lds
    buffer_load_dwordx4 v22, s[32:35], s75 offen offset:2048 lds
    buffer_load_dwordx4 v23, s[32:35], s75 offen offset:3072 lds
    s_mov_b32 s64, 1
L_common:
    s_mov_b32 s48, s24
    s_mov_b32 s49, s25
    s_mov_b32 s50, 256
    s_mov_b32 s51, 0x20000
    s_lshr_b32 s88, s2, 3
    s_cmp_ge_u32 s88, 4
    s_cselect_b32 s79, 1, 0
    s_sub_u32 s88, s88, 4
    s_lshr_b32 s78, s88, 2
    s_and_b32 s88, s88, 3
    s_and_b32 s87, s2, 7
    s_lshl2_add_u32 s77, s87, s88
    s_mov_b32 s44, s26
    s_mov_b32 s45, s27
    s_mov_b32 s46, 10092544
    s_mov_b32 s47, 0x20000
    s_mov_b32 s52, s20
    s_mov_b32 s53, s21
    s_mov_b32 s54, 1605632
    s_mov_b32 s55, 0x20000
    s_mov_b32 s56, s12
    s_mov_b32 s57, s13
    s_mov_b32 s58, 401408
    s_mov_b32 s59, 0x20000
    s_mov_b32 s60, s22
    s_mov_b32 s61, s23
    s_mov_b32 s62, 1835008
    s_mov_b32 s63, 0x20000
    s_mov_b32 s93, 0x358637bd
    v_and_b32 v2, 15, v1
    v_and_b32 v4, 3, v1
    v_cmp_eq_u32 vcc, 0, v4
    s_cmp_eq_u32 s79, 0
    s_nop 0
    v_cndmask_b32 v4, 0, 1, vcc
    s_cselect_b32 s54, 0, s54
    v_or_b32 v3, v2, v4
    v_lshlrev_b32 v2, 2, v2
    v_lshlrev_b32 v3, 2, v3
    s_lshl_b32 s87, s70, 1
    s_or_b32 s87, s87, s64
    s_cmp_lg_u32 s87, 1
    s_cbranch_scc1 KZ_1
    s_mul_i32 s87, s71, 112
    s_mul_i32 s88, s68, 7
    s_add_u32 s87, s87, s88
    s_lshl_b32 s87, s87, 7
    s_add_u32 s87, s87, 9437184
    v_lshlrev_b32 v4, 4, v1
    v_mov_b32 v5, 1073741824
    v_cmp_gt_u32 vcc, 56, v1
    v_mov_b32 v40, 0
    v_mov_b32 v41, 0
    v_mov_b32 v42, 0
    v_mov_b32 v43, 0
    v_cndmask_b32 v4, v5, v4, vcc
    buffer_store_dwordx4 v[40:43], v4, s[44:47], s87 offen sc1
KZ_1:
    v_lshrrev_b32 v4, 4, v1
    v_xor_b32 v4, v4, v1
    v_and_b32 v4, 1, v4
    v_mov_b32 v5, 0x3f803f80
    v_cmp_eq_u32 vcc, 0, v4
    v_and_b32 v6, 31, v1
    v_bfe_u32 v7, v1, 1, 3
    v_cndmask_b32 v28, 0, v5, vcc
    v_mov_b32 v29, v28
    v_mov_b32 v30, v28
    v_mov_b32 v31, v28
    v_lshrrev_b32 v4, 5, v1
    v_xor_b32 v7, v7, v4
    v_lshlrev_b32 v7, 4, v7
    v_lshl_add_u32 v248, v6, 7, v7
    v_lshlrev_b32 v4, 3, v4
    v_bfe_u32 v37, v1, 2, 2
    v_add_u32 v36, v4, v37
    v_bfe_u32 v6, v1, 4, 1
    v_lshlrev_b32 v6, 5, v6
    v_and_b32 v7, 3, v1
    v_lshl_add_u32 v38, v7, 3, v6
    s_lshl_b32 s87, s86, 4
    s_add_u32 s65, s87, 9502720
    v_and_b32 v7, 31, v1
    v_cmp_eq_u32 vcc, 31, v7
    v_lshrrev_b32 v6, 1, v1
    v_and_b32 v6, 16, v6
    v_mov_b32 v7, 1073741824
    v_cndmask_b32 v18, v7, v6, vcc
    v_and_b32 v4, 16, v1
    v_cmp_eq_u32 s[98:99], 0, v4
    v_cmp_gt_u32 s[96:97], 32, v1
    s_mul_i32 s84, s69, 28672
    s_add_u32 s84, s84, 9633792
    s_min_u32 s87, s68, 13
    s_and_b32 s88, s87, 1
    s_lshr_b32 s87, s87, 1
    s_lshl_b32 s87, s87, 12
    s_lshl_b32 s88, s88, 3
    s_add_u32 s85, s84, s87
    s_add_u32 s85, s85, s88
    s_cmp_eq_u32 s64, 1
    s_cbranch_scc1 L_kv
    s_and_b32 s90, s70, 1
    s_lshr_b32 s91, s70, 1
    s_lshl_b32 s87, s90, 13
    v_add_u32 v248, s87, v248
    v_xor_b32 v249, 32, v248
    v_xor_b32 v250, 64, v248
    v_xor_b32 v251, 96, v248
    s_lshl_b32 s87, s91, 6
    v_add_u32 v6, s87, v38
    v_bfe_u32 v7, v1, 3, 1
    v_lshlrev_b32 v7, 6, v7
    v_xor_b32 v6, v6, v7
    v_lshl_add_u32 v4, v36, 7, v6
    v_add_u32 v32, 49152, v4
    v_add_u32 v33, 98304, v4
    s_waitcnt vmcnt(7)
    s_mov_b32 s87, 0x3f803f80
    v_mov_b32 v4, 0
    v_mov_b32 v5, 0
    v_dot2c_f32_bf16 v4, s87, v8
    v_dot2c_f32_bf16 v5, v8, v8
    v_dot2c_f32_bf16 v4, s87, v9
    v_dot2c_f32_bf16 v5, v9, v9
    v_dot2c_f32_bf16 v4, s87, v10
    v_dot2c_f32_bf16 v5, v10, v10
    v_dot2c_f32_bf16 v4, s87, v11
    v_dot2c_f32_bf16 v5, v11, v11
    v_dot2c_f32_bf16 v4, s87, v12
    v_dot2c_f32_bf16 v5, v12, v12
    v_dot2c_f32_bf16 v4, s87, v13
    v_dot2c_f32_bf16 v5, v13, v13
    v_dot2c_f32_bf16 v4, s87, v14
    v_dot2c_f32_bf16 v5, v14, v14
    v_dot2c_f32_bf16 v4, s87, v15
    v_dot2c_f32_bf16 v5, v15, v15
    s_nop 1
    v_add_f32_dpp v4, v4, v4 row_shr:1 row_mask:0xf bank_mask:0xf bound_ctrl:1
    v_add_f32_dpp v5, v5, v5 row_shr:1 row_mask:0xf bank_mask:0xf bound_ctrl:1
    s_nop 0
    v_add_f32_dpp v4, v4, v4 row_shr:2 row_mask:0xf bank_mask:0xf bound_ctrl:1
    v_add_f32_dpp v5, v5, v5 row_shr:2 row_mask:0xf bank_mask:0xf bound_ctrl:1
    s_nop 0
    v_add_f32_dpp v4, v4, v4 row_shr:4 row_mask:0xf bank_mask:0xf bound_ctrl:1
    v_add_f32_dpp v5, v5, v5 row_shr:4 row_mask:0xf bank_mask:0xf bound_ctrl:1
    s_nop 0
    v_add_f32_dpp v4, v4, v4 row_shr:8 row_mask:0xf bank_mask:0xf bound_ctrl:1
    v_add_f32_dpp v5, v5, v5 row_shr:8 row_mask:0xf bank_mask:0xf bound_ctrl:1
    s_nop 0
    v_add_f32_dpp v4, v4, v4 row_bcast:15 row_mask:0xa bank_mask:0xf
    v_add_f32_dpp v5, v5, v5 row_bcast:15 row_mask:0xa bank_mask:0xf
    v_mul_f32 v4, 0x3b124925, v4
    v_mul_f32 v5, 0x3b124925, v5
    v_fma_f32 v5, -v4, v4, v5
    v_max_f32 v5, 0, v5
    v_cvt_pk_bf16_f32 v6, v4, v5
    v_lshlrev_b32 v4, 16, v6
    v_and_b32 v5, 0xffff0000, v6
    v_add_f32 v5, 0x3727c5ac, v5
    v_cvt_pk_bf16_f32 v5, v5, v5
    v_lshlrev_b32 v5, 16, v5
    v_sqrt_f32 v5, v5
    s_nop 0
    v_cvt_pk_bf16_f32 v5, v5, v5
    v_lshlrev_b32 v5, 16, v5
    v_rcp_f32 v8, v5
    s_nop 0
    v_mul_f32 v10, v4, v8
    v_sub_f32 v10, 0, v10
    s_lshl_b32 s73, s72, 7
    s_add_u32 s73, s73, s43
    s_mul_i32 s74, s72, 229376
    s_mul_i32 s75, s72, s81
    s_add_u32 s72, s72, 1
    s_cmp_eq_u32 s72, 7
    s_cselect_b32 s72, 0, s72
    s_add_u32 m0, s6, 16384
    s_nop 0
    buffer_load_dwordx4 v16, s[28:31], s73 offen offset:0 lds
    buffer_load_dwordx4 v17, s[28:31], s73 offen offset:1024 lds
    buffer_load_dwordx4 v252, s[28:31], s73 offen offset:2048 lds
    buffer_load_dwordx4 v253, s[28:31], s73 offen offset:3072 lds
    s_add_u32 m0, s7, 73728
    s_nop 0
    buffer_load_dwordx4 v20, s[32:35], s74 offen offset:0 lds
    buffer_load_dwordx4 v21, s[32:35], s74 offen offset:1024 lds
    buffer_load_dwordx4 v22, s[32:35], s74 offen offset:2048 lds
    buffer_load_dwordx4 v23, s[32:35], s74 offen offset:3072 lds
    s_add_u32 m0, s7, 77824
    s_nop 0
    buffer_load_dwordx4 v24, s[36:39], s75 offen offset:0 lds
    buffer_load_dwordx4 v25, s[36:39], s75 offen offset:1024 lds
    buffer_load_dword v27, off, s[48:51], 0 sc1
    s_mov_b32 s64, 2
    s_branch L_pub
L_t1:
    s_branch L_eq
L_t2:
    s_mov_b32 s64, 0
    s_waitcnt vmcnt(12)
    s_barrier
    ds_read_b128 v[48:51], v248 offset:0
    ds_read_b64_tr_b16 v[56:57], v32 offset:0
    ds_read_b64_tr_b16 v[58:59], v32 offset:512
    ds_read_b128 v[52:55], v248 offset:4096
    ds_read_b64_tr_b16 v[60:61], v32 offset:2048
    ds_read_b64_tr_b16 v[62:63], v32 offset:2560
    ds_read_b64_tr_b16 v[64:65], v32 offset:4096
    ds_read_b64_tr_b16 v[66:67], v32 offset:4608
    s_lshl_b32 s73, s72, 7
    s_add_u32 s73, s73, s43
    s_mul_i32 s74, s72, 229376
    s_mul_i32 s75, s72, s81
    s_add_u32 s72, s72, 1
    s_cmp_eq_u32 s72, 7
    s_cselect_b32 s72, 0, s72
    s_waitcnt lgkmcnt(4)
    v_mfma_f32_32x32x16_bf16 v[88:103], v[56:59], v[48:51], 0
    ds_read_b128 v[68:71], v249 offset:0
    ds_read_b64_tr_b16 v[76:77], v32 offset:6144
    s_cmp_lt_u32 s68, 14
    s_cselect_b32 s87, s90, 1
    s_add_u32 m0, s6, 32768
    v_mfma_f32_32x32x16_bf16 v[104:119], v[56:59], v[52:55], 0
    buffer_load_dwordx4 v16, s[28:31], s73 offen offset:0 lds
    ds_read_b64_tr_b16 v[78:79], v32 offset:6656
    ds_read_b128 v[72:75], v249 offset:4096
    s_lshl_b32 s87, s87, 30
    s_waitcnt lgkmcnt(4)
    v_mfma_f32_32x32x16_bf16 v[120:135], v[60:63], v[48:51], 0
    ds_read_b64_tr_b16 v[80:81], v32 offset:8192
    ds_read_b64_tr_b16 v[82:83], v32 offset:8704
    s_lshl_b32 s88, s91, 9
    v_mfma_f32_32x32x16_bf16 v[136:151], v[60:63], v[52:55], 0
    buffer_load_dwordx4 v17, s[28:31], s73 offen offset:1024 lds
    ds_read_b64_tr_b16 v[84:85], v32 offset:10240
    ds_read_b64_tr_b16 v[86:87], v32 offset:10752
    s_add_u32 s87, s87, s88
    v_mfma_f32_32x32x16_bf16 v[152:167], v[64:67], v[48:51], 0
    buffer_load_dwordx4 v252, s[28:31], s73 offen offset:2048 lds
    v_and_b32 v4, 31, v1
    v_mfma_f32_32x32x16_bf16 v[168:183], v[64:67], v[52:55], 0
    buffer_load_dwordx4 v253, s[28:31], s73 offen offset:3072 lds
    v_mfma_f32_16x16x32_bf16 v[36:39], v[28:31], v[56:59], 0
    v_mfma_f32_16x16x32_bf16 v[40:43], v[28:31], v[60:63], 0
    v_mfma_f32_16x16x32_bf16 v[44:47], v[28:31], v[64:67], 0
    s_waitcnt lgkmcnt(4)
    v_mfma_f32_32x32x16_bf16 v[88:103], v[76:79], v[68:71], v[88:103]
    ds_read_b128 v[48:51], v250 offset:0
    ds_read_b64_tr_b16 v[56:57], v32 offset:12288
    v_lshrrev_b32 v5, 5, v1
    s_add_u32 m0, s7, 98304
    v_mfma_f32_32x32x16_bf16 v[104:119], v[76:79], v[72:75], v[104:119]
    buffer_load_dwordx4 v20, s[32:35], s74 offen offset:0 lds
    ds_read_b64_tr_b16 v[58:59], v32 offset:12800
    ds_read_b128 v[52:55], v250 offset:4096
    v_lshlrev_b32 v5, 10, v5
    s_waitcnt lgkmcnt(4)
    v_mfma_f32_32x32x16_bf16 v[120:135], v[80:83], v[68:71], v[120:135]
    ds_read_b64_tr_b16 v[60:61], v32 offset:14336
    ds_read_b64_tr_b16 v[62:63], v32 offset:14848
    v_lshl_add_u32 v5, v4, 4, v5
    v_mfma_f32_32x32x16_bf16 v[136:151], v[80:83], v[72:75], v[136:151]
    buffer_load_dwordx4 v21, s[32:35], s74 offen offset:1024 lds
    ds_read_b64_tr_b16 v[64:65], v32 offset:16384
    ds_read_b64_tr_b16 v[66:67], v32 offset:16896
    v_add_u32 v26, s87, v5
    v_mfma_f32_32x32x16_bf16 v[152:167], v[84:87], v[68:71], v[152:167]
    buffer_load_dwordx4 v22, s[32:35], s74 offen offset:2048 lds
    v_lshl_add_u32 v12, v4, 4, s87
    v_mfma_f32_32x32x16_bf16 v[168:183], v[84:87], v[72:75], v[168:183]
    buffer_load_dwordx4 v23, s[32:35], s74 offen offset:3072 lds
    v_mfma_f32_16x16x32_bf16 v[36:39], v[28:31], v[76:79], v[36:39]
    v_mfma_f32_16x16x32_bf16 v[40:43], v[28:31], v[80:83], v[40:43]
    v_mfma_f32_16x16x32_bf16 v[44:47], v[28:31], v[84:87], v[44:47]
    s_waitcnt lgkmcnt(4)
    v_mfma_f32_32x32x16_bf16 v[88:103], v[56:59], v[48:51], v[88:103]
    ds_read_b128 v[68:71], v251 offset:0
    ds_read_b64_tr_b16 v[76:77], v32 offset:18432
    s_nop 1
    s_add_u32 m0, s7, 102400
    v_mfma_f32_32x32x16_bf16 v[104:119], v[56:59], v[52:55], v[104:119]
    buffer_load_dwordx4 v24, s[36:39], s75 offen offset:0 lds
    ds_read_b64_tr_b16 v[78:79], v32 offset:18944
    ds_read_b128 v[72:75], v251 offset:4096
    v_cndmask_b32 v36, v37, v36, s[98:99]
    s_waitcnt lgkmcnt(4)
    v_mfma_f32_32x32x16_bf16 v[120:135], v[60:63], v[48:51], v[120:135]
    ds_read_b64_tr_b16 v[80:81], v32 offset:20480
    ds_read_b64_tr_b16 v[82:83], v32 offset:20992
    v_cndmask_b32 v40, v41, v40, s[98:99]
    v_mfma_f32_32x32x16_bf16 v[136:151], v[60:63], v[52:55], v[136:151]
    buffer_load_dwordx4 v25, s[36:39], s75 offen offset:1024 lds
    ds_read_b64_tr_b16 v[84:85], v32 offset:22528
    ds_read_b64_tr_b16 v[86:87], v32 offset:23040
    v_cndmask_b32 v14, v45, v44, s[98:99]
    v_mfma_f32_32x32x16_bf16 v[152:167], v[64:67], v[48:51], v[152:167]
    v_cndmask_b32 v4, v40, v36, s[96:97]
    v_mfma_f32_32x32x16_bf16 v[168:183], v[64:67], v[52:55], v[168:183]
    s_waitcnt vmcnt(11) lgkmcnt(0)
    s_barrier
    v_mfma_f32_32x32x16_bf16 v[88:103], v[76:79], v[68:71], v[88:103]
    ds_read_b128 v[48:51], v248 offset:16384
    ds_read_b64_tr_b16 v[56:57], v32 offset:24576
    s_lshl_b32 s73, s72, 7
    s_add_u32 s73, s73, s43
    s_mul_i32 s74, s72, 229376
    s_mul_i32 s75, s72, s81
    s_add_u32 s72, s72, 1
    s_cmp_eq_u32 s72, 7
    s_cselect_b32 s72, 0, s72
    s_waitcnt vmcnt(10)
    s_add_u32 m0, s6, 0
    v_mfma_f32_32x32x16_bf16 v[104:119], v[76:79], v[72:75], v[104:119]
    buffer_load_dwordx4 v16, s[28:31], s73 offen offset:0 lds
    ds_read_b64_tr_b16 v[58:59], v32 offset:25088
    ds_read_b128 v[52:55], v248 offset:20480
    s_mov_b32 s92, 30000
NT_2:
    v_readfirstlane_b32 s3, v27
    s_nop 0
    s_sub_u32 s89, s3, s66
    s_add_u32 s89, s89, 4096
    s_lshr_b32 s89, s89, 13
    s_andn2_b32 s67, 1, s3
    s_or_b32 s89, s89, s67
    s_cbranch_scc0 ND_3
    s_sub_u32 s92, s92, 1
    s_cmp_eq_u32 s92, 0
    s_cbranch_scc1 ND_3
    buffer_load_dword v27, off, s[48:51], 0 sc1
    s_waitcnt vmcnt(0)
    s_branch NT_2
ND_3:
    v_mfma_f32_32x32x16_bf16 v[120:135], v[80:83], v[68:71], v[120:135]
    ds_read_b64_tr_b16 v[60:61], v32 offset:26624
    ds_read_b64_tr_b16 v[62:63], v32 offset:27136
    v_mfma_f32_32x32x16_bf16 v[136:151], v[80:83], v[72:75], v[136:151]
    buffer_load_dwordx4 v17, s[28:31], s73 offen offset:1024 lds
    ds_read_b64_tr_b16 v[64:65], v32 offset:28672
    ds_read_b64_tr_b16 v[66:67], v32 offset:29184
    v_mov_b32 v9, s3
    v_mfma_f32_32x32x16_bf16 v[152:167], v[84:87], v[68:71], v[152:167]
    v_mov_b32 v11, s3
    v_mfma_f32_32x32x16_bf16 v[168:183], v[84:87], v[72:75], v[168:183]
    buffer_load_dwordx4 v252, s[28:31], s73 offen offset:2048 lds
    s_waitcnt lgkmcnt(4)
    v_mfma_f32_32x32x16_bf16 v[88:103], v[56:59], v[48:51], v[88:103]
    ds_read_b128 v[68:71], v249 offset:16384
    ds_read_b64_tr_b16 v[76:77], v32 offset:30720
    v_mov_b32 v5, s3
    v_mfma_f32_32x32x16_bf16 v[104:119], v[56:59], v[52:55], v[104:119]
    buffer_load_dwordx4 v253, s[28:31], s73 offen offset:3072 lds
    ds_read_b64_tr_b16 v[78:79], v32 offset:31232
    ds_read_b128 v[72:75], v249 offset:20480
    buffer_store_dwordx4 v[8:11], v18, s[44:47], s65 offen sc1
    s_waitcnt lgkmcnt(4)
    v_mfma_f32_32x32x16_bf16 v[120:135], v[60:63], v[48:51], v[120:135]
    ds_read_b64_tr_b16 v[80:81], v32 offset:32768
    ds_read_b64_tr_b16 v[82:83], v32 offset:33280
    v_mov_b32 v15, s3
    s_add_u32 m0, s7, 49152
    v_mfma_f32_32x32x16_bf16 v[136:151], v[60:63], v[52:55], v[136:151]
    buffer_load_dwordx4 v20, s[32:35], s74 offen offset:0 lds
    ds_read_b64_tr_b16 v[84:85], v32 offset:34816
    ds_read_b64_tr_b16 v[86:87], v32 offset:35328
    buffer_store_dwordx2 v[4:5], v26, s[44:47], s85 offen sc1
    v_mfma_f32_32x32x16_bf16 v[152:167], v[64:67], v[48:51], v[152:167]
    buffer_store_dwordx2 v[14:15], v12, s[44:47], s85 offen offset:2048 sc1
    v_mfma_f32_32x32x16_bf16 v[168:183], v[64:67], v[52:55], v[168:183]
    buffer_load_dwordx4 v21, s[32:35], s74 offen offset:1024 lds
    s_waitcnt lgkmcnt(4)
    v_mfma_f32_32x32x16_bf16 v[88:103], v[76:79], v[68:71], v[88:103]
    ds_read_b128 v[48:51], v250 offset:16384
    ds_read_b64_tr_b16 v[56:57], v32 offset:36864
    v_mfma_f32_32x32x16_bf16 v[104:119], v[76:79], v[72:75], v[104:119]
    buffer_load_dwordx4 v22, s[32:35], s74 offen offset:2048 lds
    ds_read_b64_tr_b16 v[58:59], v32 offset:37376
    ds_read_b128 v[52:55], v250 offset:20480
    s_waitcnt lgkmcnt(4)
    v_mfma_f32_32x32x16_bf16 v[120:135], v[80:83], v[68:71], v[120:135]
    ds_read_b64_tr_b16 v[60:61], v32 offset:38912
    ds_read_b64_tr_b16 v[62:63], v32 offset:39424
    v_mfma_f32_32x32x16_bf16 v[136:151], v[80:83], v[72:75], v[136:151]
    buffer_load_dwordx4 v23, s[32:35], s74 offen offset:3072 lds
    ds_read_b64_tr_b16 v[64:65], v32 offset:40960
    ds_read_b64_tr_b16 v[66:67], v32 offset:41472
    v_mfma_f32_32x32x16_bf16 v[152:167], v[84:87], v[68:71], v[152:167]
    s_add_u32 m0, s7, 53248
    v_mfma_f32_32x32x16_bf16 v[168:183], v[84:87], v[72:75], v[168:183]
    buffer_load_dwordx4 v24, s[36:39], s75 offen offset:0 lds
    s_waitcnt lgkmcnt(4)
    v_mfma_f32_32x32x16_bf16 v[88:103], v[56:59], v[48:51], v[88:103]
    ds_read_b128 v[68:71], v251 offset:16384
    ds_read_b64_tr_b16 v[76:77], v32 offset:43008
    v_lshlrev_b32 v4, 16, v19
    v_mfma_f32_32x32x16_bf16 v[104:119], v[56:59], v[52:55], v[104:119]
    buffer_load_dwordx4 v25, s[36:39], s75 offen offset:1024 lds
    ds_read_b64_tr_b16 v[78:79], v32 offset:43520
    ds_read_b128 v[72:75], v251 offset:20480
    v_and_b32 v5, 0xffff0000, v19
    s_waitcnt lgkmcnt(4)
    s_nop 0
    v_mfma_f32_32x32x16_bf16 v[120:135], v[60:63], v[48:51], v[120:135]
    ds_read_b64_tr_b16 v[80:81], v32 offset:45056
    ds_read_b64_tr_b16 v[82:83], v32 offset:45568
    v_mul_f32 v4, 0x3fb8aa3b, v4
    v_mfma_f32_32x32x16_bf16 v[136:151], v[60:63], v[52:55], v[136:151]
    ds_read_b64_tr_b16 v[84:85], v32 offset:47104
    ds_read_b64_tr_b16 v[86:87], v32 offset:47616
    v_mul_f32 v5, 0x3fb8aa3b, v5
    v_mfma_f32_32x32x16_bf16 v[152:167], v[64:67], v[48:51], v[152:167]
    v_min_u32 v6, 127, v0
    v_mfma_f32_32x32x16_bf16 v[168:183], v[64:67], v[52:55], v[168:183]
    s_waitcnt vmcnt(13) lgkmcnt(0)
    s_barrier
    v_mfma_f32_32x32x16_bf16 v[88:103], v[76:79], v[68:71], v[88:103]
    ds_read_b128 v[48:51], v248 offset:32768
    ds_read_b64_tr_b16 v[56:57], v33 offset:0
    s_lshl_b32 s73, s72, 7
    s_add_u32 s73, s73, s43
    s_mul_i32 s74, s72, 229376
    s_mul_i32 s75, s72, s81
    s_add_u32 s72, s72, 1
    s_cmp_eq_u32 s72, 7
    s_cselect_b32 s72, 0, s72
    v_lshlrev_b32_e64 v6, 3, v6
    s_add_u32 m0, s6, 16384
    v_mfma_f32_32x32x16_bf16 v[104:119], v[76:79], v[72:75], v[104:119]
    buffer_load_dwordx4 v16, s[28:31], s73 offen offset:0 lds
    ds_read_b64_tr_b16 v[58:59], v33 offset:512
    ds_read_b128 v[52:55], v248 offset:36864
    v_add_u32 v6, 160768, v6
    v_mfma_f32_32x32x16_bf16 v[120:135], v[80:83], v[68:71], v[120:135]
    ds_read_b64_tr_b16 v[60:61], v33 offset:2048
    ds_read_b64_tr_b16 v[62:63], v33 offset:2560
    ds_write_b64 v6, v[4:5]
    v_mfma_f32_32x32x16_bf16 v[136:151], v[80:83], v[72:75], v[136:151]
    buffer_load_dwordx4 v17, s[28:31], s73 offen offset:1024 lds
    ds_read_b64_tr_b16 v[64:65], v33 offset:4096
    ds_read_b64_tr_b16 v[66:67], v33 offset:4608
    v_and_b32 v4, 31, v1
    v_mfma_f32_32x32x16_bf16 v[152:167], v[84:87], v[68:71], v[152:167]
    v_lshlrev_b32 v18, 4, v4
    v_mfma_f32_32x32x16_bf16 v[168:183], v[84:87], v[72:75], v[168:183]
    buffer_load_dwordx4 v252, s[28:31], s73 offen offset:2048 lds
    s_lshl_b32 s87, s68, 1
    s_waitcnt lgkmcnt(5)
    v_mfma_f32_32x32x16_bf16 v[88:103], v[56:59], v[48:51], v[88:103]
    ds_read_b128 v[68:71], v249 offset:32768
    ds_read_b64_tr_b16 v[76:77], v33 offset:6144
    s_add_u32 s87, s87, s90
    v_mfma_f32_32x32x16_bf16 v[104:119], v[56:59], v[52:55], v[104:119]
    buffer_load_dwordx4 v253, s[28:31], s73 offen offset:3072 lds
    ds_read_b64_tr_b16 v[78:79], v33 offset:6656
    ds_read_b128 v[72:75], v249 offset:36864
    s_lshl_b32 s87, s87, 10
    s_waitcnt lgkmcnt(4)
    v_mfma_f32_32x32x16_bf16 v[120:135], v[60:63], v[48:51], v[120:135]
    ds_read_b64_tr_b16 v[80:81], v33 offset:8192
    ds_read_b64_tr_b16 v[82:83], v33 offset:8704
    s_add_u32 s65, s87, 9502720
    s_add_u32 m0, s7, 73728
    v_mfma_f32_32x32x16_bf16 v[136:151], v[60:63], v[52:55], v[136:151]
    buffer_load_dwordx4 v20, s[32:35], s74 offen offset:0 lds
    ds_read_b64_tr_b16 v[84:85], v33 offset:10240
    ds_read_b64_tr_b16 v[86:87], v33 offset:10752
    s_lshl_b32 s88, s91, 7
    v_mfma_f32_32x32x16_bf16 v[152:167], v[64:67], v[48:51], v[152:167]
    v_lshrrev_b32 v4, 5, v1
    v_mfma_f32_32x32x16_bf16 v[168:183], v[64:67], v[52:55], v[168:183]
    buffer_load_dwordx4 v21, s[32:35], s74 offen offset:1024 lds
    v_lshlrev_b32 v4, 4, v4
    s_waitcnt lgkmcnt(4)
    v_mfma_f32_32x32x16_bf16 v[88:103], v[76:79], v[68:71], v[88:103]
    ds_read_b128 v[48:51], v250 offset:32768
    ds_read_b64_tr_b16 v[56:57], v33 offset:12288
    s_add_u32 s88, s88, 159744
    v_mfma_f32_32x32x16_bf16 v[104:119], v[76:79], v[72:75], v[104:119]
    buffer_load_dwordx4 v22, s[32:35], s74 offen offset:2048 lds
    ds_read_b64_tr_b16 v[58:59], v33 offset:12800
    ds_read_b128 v[52:55], v250 offset:36864
    v_add_u32 v35, s88, v4
    s_waitcnt lgkmcnt(4)
    v_mfma_f32_32x32x16_bf16 v[120:135], v[80:83], v[68:71], v[120:135]
    ds_read_b64_tr_b16 v[60:61], v33 offset:14336
    ds_read_b64_tr_b16 v[62:63], v33 offset:14848
    s_mul_i32 s87, s90, 280
    v_mfma_f32_32x32x16_bf16 v[136:151], v[80:83], v[72:75], v[136:151]
    buffer_load_dwordx4 v23, s[32:35], s74 offen offset:3072 lds
    ds_read_b64_tr_b16 v[64:65], v33 offset:16384
    ds_read_b64_tr_b16 v[66:67], v33 offset:16896
    s_lshl_b32 s88, s91, 1
    v_mfma_f32_32x32x16_bf16 v[152:167], v[84:87], v[68:71], v[152:167]
    s_add_u32 s87, s87, s88
    s_add_u32 m0, s7, 77824
    v_mfma_f32_32x32x16_bf16 v[168:183], v[84:87], v[72:75], v[168:183]
    buffer_load_dwordx4 v24, s[36:39], s75 offen offset:0 lds
    s_lshl_b32 s87, s87, 10
    s_waitcnt lgkmcnt(4)
    v_mfma_f32_32x32x16_bf16 v[88:103], v[56:59], v[48:51], v[88:103]
    ds_read_b128 v[68:71], v251 offset:32768
    ds_read_b64_tr_b16 v[76:77], v33 offset:18432
    v_lshl_add_u32 v34, v1, 4, s87
    v_mfma_f32_32x32x16_bf16 v[104:119], v[56:59], v[52:55], v[104:119]
    buffer_load_dwordx4 v25, s[36:39], s75 offen offset:1024 lds
    ds_read_b64_tr_b16 v[78:79], v33 offset:18944
    ds_read_b128 v[72:75], v251 offset:36864
    v_min_u32 v4, 191, v0
    s_waitcnt lgkmcnt(4)
    v_mfma_f32_32x32x16_bf16 v[120:135], v[60:63], v[48:51], v[120:135]
    ds_read_b64_tr_b16 v[80:81], v33 offset:20480
    ds_read_b64_tr_b16 v[82:83], v33 offset:20992
    v_lshlrev_b32 v26, 4, v4
    v_mfma_f32_32x32x16_bf16 v[136:151], v[60:63], v[52:55], v[136:151]
    ds_read_b64_tr_b16 v[84:85], v33 offset:22528
    ds_read_b64_tr_b16 v[86:87], v33 offset:23040
    v_mov_b32 v30, 0x35800000
    v_mfma_f32_32x32x16_bf16 v[152:167], v[64:67], v[48:51], v[152:167]
    v_mov_b32 v31, 0x35800000
    v_mfma_f32_32x32x16_bf16 v[168:183], v[64:67], v[52:55], v[168:183]
    s_add_u32 s13, s84, 0
    s_lshl_b32 s22, s2, 2
    s_add_u32 s22, s22, s70
    s_lshl_b32 s22, s22, 11
    s_cmp_lt_u32 s22, 1605632
    s_cselect_b32 s8, s52, s56
    s_cselect_b32 s9, s53, s57
    s_mov_b32 s10, 401408
    s_cselect_b32 s10, 1605632, s10
    s_cselect_b32 s23, 0, 1605632
    s_mov_b32 s11, 0x20000
    s_sub_u32 s12, s22, s23
    v_and_b32 v255, 15, v1
    v_lshlrev_b32 v255, 7, v255
    buffer_load_dword v254, v255, s[8:11], s12 offen
    s_waitcnt vmcnt(11) lgkmcnt(0)
    s_barrier
    v_mfma_f32_32x32x16_bf16 v[88:103], v[76:79], v[68:71], v[88:103]
    ds_read_b128 v[48:51], v248 offset:0
    ds_read_b64_tr_b16 v[56:57], v32 offset:0
    s_lshl_b32 s73, s72, 7
    s_add_u32 s73, s73, s43
    s_mul_i32 s74, s72, 229376
    s_mul_i32 s75, s72, s81
    s_add_u32 s72, s72, 1
    s_cmp_eq_u32 s72, 7
    s_cselect_b32 s72, 0, s72
    s_add_u32 s14, s84, 4096
    s_add_u32 m0, s6, 32768
    v_mfma_f32_32x32x16_bf16 v[104:119], v[76:79], v[72:75], v[104:119]
    buffer_load_dwordx4 v16, s[28:31], s73 offen offset:0 lds
    ds_read_b64_tr_b16 v[58:59], v32 offset:512
    ds_read_b128 v[52:55], v248 offset:4096
    s_add_u32 s15, s84, 8192
    v_mfma_f32_32x32x16_bf16 v[120:135], v[80:83], v[68:71], v[120:135]
    ds_read_b64_tr_b16 v[60:61], v32 offset:2048
    ds_read_b64_tr_b16 v[62:63], v32 offset:2560
    s_add_u32 s16, s84, 12288
    v_mfma_f32_32x32x16_bf16 v[136:151], v[80:83], v[72:75], v[136:151]
    buffer_load_dwordx4 v17, s[28:31], s73 offen offset:1024 lds
    ds_read_b64_tr_b16 v[64:65], v32 offset:4096
    ds_read_b64_tr_b16 v[66:67], v32 offset:4608
    s_add_u32 s17, s84, 16384
    v_mfma_f32_32x32x16_bf16 v[152:167], v[84:87], v[68:71], v[152:167]
    s_add_u32 s18, s84, 20480
    v_mfma_f32_32x32x16_bf16 v[168:183], v[84:87], v[72:75], v[168:183]
    buffer_load_dwordx4 v252, s[28:31], s73 offen offset:2048 lds
    s_add_u32 s19, s84, 24576
    s_waitcnt lgkmcnt(4)
    v_mfma_f32_32x32x16_bf16 v[88:103], v[56:59], v[48:51], v[88:103]
    ds_read_b128 v[68:71], v249 offset:0
    ds_read_b64_tr_b16 v[76:77], v32 offset:6144
    v_mfma_f32_32x32x16_bf16 v[104:119], v[56:59], v[52:55], v[104:119]
    buffer_load_dwordx4 v253, s[28:31], s73 offen offset:3072 lds
    ds_read_b64_tr_b16 v[78:79], v32 offset:6656
    ds_read_b128 v[72:75], v249 offset:4096
    s_waitcnt lgkmcnt(4)
    v_mfma_f32_32x32x16_bf16 v[120:135], v[60:63], v[48:51], v[120:135]
    ds_read_b64_tr_b16 v[80:81], v32 offset:8192
    ds_read_b64_tr_b16 v[82:83], v32 offset:8704
    s_add_u32 m0, s7, 98304
    v_mfma_f32_32x32x16_bf16 v[136:151], v[60:63], v[52:55], v[136:151]
    buffer_load_dwordx4 v20, s[32:35], s74 offen offset:0 lds
    ds_read_b64_tr_b16 v[84:85], v32 offset:10240
    ds_read_b64_tr_b16 v[86:87], v32 offset:10752
    v_mfma_f32_32x32x16_bf16 v[152:167], v[64:67], v[48:51], v[152:167]
    v_mfma_f32_32x32x16_bf16 v[168:183], v[64:67], v[52:55], v[168:183]
    buffer_load_dwordx4 v21, s[32:35], s74 offen offset:1024 lds
    s_waitcnt lgkmcnt(4)
    v_mfma_f32_32x32x16_bf16 v[88:103], v[76:79], v[68:71], v[88:103]
    ds_read_b128 v[48:51], v250 offset:0
    ds_read_b64_tr_b16 v[56:57], v32 offset:12288
    v_mfma_f32_32x32x16_bf16 v[104:119], v[76:79], v[72:75], v[104:119]
    buffer_load_dwordx4 v22, s[32:35], s74 offen offset:2048 lds
    ds_read_b64_tr_b16 v[58:59], v32 offset:12800
    ds_read_b128 v[52:55], v250 offset:4096
    s_waitcnt lgkmcnt(4)
    v_mfma_f32_32x32x16_bf16 v[120:135], v[80:83], v[68:71], v[120:135]
    ds_read_b64_tr_b16 v[60:61], v32 offset:14336
    ds_read_b64_tr_b16 v[62:63], v32 offset:14848
    v_mfma_f32_32x32x16_bf16 v[136:151], v[80:83], v[72:75], v[136:151]
    buffer_load_dwordx4 v23, s[32:35], s74 offen offset:3072 lds
    ds_read_b64_tr_b16 v[64:65], v32 offset:16384
    ds_read_b64_tr_b16 v[66:67], v32 offset:16896
    v_mfma_f32_32x32x16_bf16 v[152:167], v[84:87], v[68:71], v[152:167]
    s_add_u32 m0, s7, 102400
    v_mfma_f32_32x32x16_bf16 v[168:183], v[84:87], v[72:75], v[168:183]
    buffer_load_dwordx4 v24, s[36:39], s75 offen offset:0 lds
    s_waitcnt lgkmcnt(4)
    v_mfma_f32_32x32x16_bf16 v[88:103], v[56:59], v[48:51], v[88:103]
    ds_read_b128 v[68:71], v251 offset:0
    ds_read_b64_tr_b16 v[76:77], v32 offset:18432
    v_mfma_f32_32x32x16_bf16 v[104:119], v[56:59], v[52:55], v[104:119]
    buffer_load_dwordx4 v25, s[36:39], s75 offen offset:1024 lds
    ds_read_b64_tr_b16 v[78:79], v32 offset:18944
    ds_read_b128 v[72:75], v251 offset:4096
    s_waitcnt lgkmcnt(4)
    v_mfma_f32_32x32x16_bf16 v[120:135], v[60:63], v[48:51], v[120:135]
    ds_read_b64_tr_b16 v[80:81], v32 offset:20480
    ds_read_b64_tr_b16 v[82:83], v32 offset:20992
    v_mfma_f32_32x32x16_bf16 v[136:151], v[60:63], v[52:55], v[136:151]
    ds_read_b64_tr_b16 v[84:85], v32 offset:22528
    ds_read_b64_tr_b16 v[86:87], v32 offset:23040
    v_mfma_f32_32x32x16_bf16 v[152:167], v[64:67], v[48:51], v[152:167]
    v_mfma_f32_32x32x16_bf16 v[168:183], v[64:67], v[52:55], v[168:183]
    s_waitcnt vmcnt(11) lgkmcnt(0)
    s_barrier
    v_mfma_f32_32x32x16_bf16 v[88:103], v[76:79], v[68:71], v[88:103]
    ds_read_b128 v[48:51], v248 offset:16384
    ds_read_b64_tr_b16 v[56:57], v32 offset:24576
    s_lshl_b32 s73, s72, 7
    s_add_u32 s73, s73, s43
    s_mul_i32 s74, s72, 229376
    s_mul_i32 s75, s72, s81
    s_add_u32 s72, s72, 1
    s_cmp_eq_u32 s72, 7
    s_cselect_b32 s72, 0, s72
    s_add_u32 m0, s6, 0
    s_nop 0
    v_mfma_f32_32x32x16_bf16 v[104:119], v[76:79], v[72:75], v[104:119]
    buffer_load_dwordx4 v16, s[28:31], s73 offen offset:0 lds
    ds_read_b64_tr_b16 v[58:59], v32 offset:25088
    ds_read_b128 v[52:55], v248 offset:20480
    v_mfma_f32_32x32x16_bf16 v[120:135], v[80:83], v[68:71], v[120:135]
    ds_read_b64_tr_b16 v[60:61], v32 offset:26624
    ds_read_b64_tr_b16 v[62:63], v32 offset:27136
    v_mfma_f32_32x32x16_bf16 v[136:151], v[80:83], v[72:75], v[136:151]
    buffer_load_dwordx4 v17, s[28:31], s73 offen offset:1024 lds
    ds_read_b64_tr_b16 v[64:65], v32 offset:28672
    ds_read_b64_tr_b16 v[66:67], v32 offset:29184
    v_mfma_f32_32x32x16_bf16 v[152:167], v[84:87], v[68:71], v[152:167]
    v_mfma_f32_32x32x16_bf16 v[168:183], v[84:87], v[72:75], v[168:183]
    buffer_load_dwordx4 v252, s[28:31], s73 offen offset:2048 lds
    s_waitcnt lgkmcnt(4)
    v_mfma_f32_32x32x16_bf16 v[88:103], v[56:59], v[48:51], v[88:103]
    ds_read_b128 v[68:71], v249 offset:16384
    ds_read_b64_tr_b16 v[76:77], v32 offset:30720
    v_mfma_f32_32x32x16_bf16 v[104:119], v[56:59], v[52:55], v[104:119]
    buffer_load_dwordx4 v253, s[28:31], s73 offen offset:3072 lds
    ds_read_b64_tr_b16 v[78:79], v32 offset:31232
    ds_read_b128 v[72:75], v249 offset:20480
    s_waitcnt lgkmcnt(4)
    v_mfma_f32_32x32x16_bf16 v[120:135], v[60:63], v[48:51], v[120:135]
    ds_read_b64_tr_b16 v[80:81], v32 offset:32768
    ds_read_b64_tr_b16 v[82:83], v32 offset:33280
    s_add_u32 m0, s7, 49152
    v_mfma_f32_32x32x16_bf16 v[136:151], v[60:63], v[52:55], v[136:151]
    buffer_load_dwordx4 v20, s[32:35], s74 offen offset:0 lds
    ds_read_b64_tr_b16 v[84:85], v32 offset:34816
    ds_read_b64_tr_b16 v[86:87], v32 offset:35328
    v_mfma_f32_32x32x16_bf16 v[152:167], v[64:67], v[48:51], v[152:167]
    v_mfma_f32_32x32x16_bf16 v[168:183], v[64:67], v[52:55], v[168:183]
    buffer_load_dwordx4 v21, s[32:35], s74 offen offset:1024 lds
    s_waitcnt lgkmcnt(4)
    v_mfma_f32_32x32x16_bf16 v[88:103], v[76:79], v[68:71], v[88:103]
    ds_read_b128 v[48:51], v250 offset:16384
    ds_read_b64_tr_b16 v[56:57], v32 offset:36864
    s_lshl_b32 s86, s68, 8
    v_mfma_f32_32x32x16_bf16 v[104:119], v[76:79], v[72:75], v[104:119]
    buffer_load_dwordx4 v22, s[32:35], s74 offen offset:2048 lds
    ds_read_b64_tr_b16 v[58:59], v32 offset:37376
    ds_read_b128 v[52:55], v250 offset:20480
    s_lshl2_add_u32 s86, s69, s86
    s_waitcnt lgkmcnt(4)
    v_mfma_f32_32x32x16_bf16 v[120:135], v[80:83], v[68:71], v[120:135]
    ds_read_b64_tr_b16 v[60:61], v32 offset:38912
    ds_read_b64_tr_b16 v[62:63], v32 offset:39424
    v_mfma_f32_32x32x16_bf16 v[136:151], v[80:83], v[72:75], v[136:151]
    buffer_load_dwordx4 v23, s[32:35], s74 offen offset:3072 lds
    ds_read_b64_tr_b16 v[64:65], v32 offset:40960
    ds_read_b64_tr_b16 v[66:67], v32 offset:41472
    s_add_u32 s67, s86, 9568256
    v_mfma_f32_32x32x16_bf16 v[152:167], v[84:87], v[68:71], v[152:167]
    s_add_u32 s86, s86, 9572352
    s_add_u32 m0, s7, 53248
    v_mfma_f32_32x32x16_bf16 v[168:183], v[84:87], v[72:75], v[168:183]
    buffer_load_dwordx4 v24, s[36:39], s75 offen offset:0 lds
    s_waitcnt lgkmcnt(4)
    v_mfma_f32_32x32x16_bf16 v[88:103], v[56:59], v[48:51], v[88:103]
    ds_read_b128 v[68:71], v251 offset:16384
    ds_read_b64_tr_b16 v[76:77], v32 offset:43008
    s_mov_b32 s94, 0xc1a00000
    v_mfma_f32_32x32x16_bf16 v[104:119], v[56:59], v[52:55], v[104:119]
    buffer_load_dwordx4 v25, s[36:39], s75 offen offset:1024 lds
    ds_read_b64_tr_b16 v[78:79], v32 offset:43520
    ds_read_b128 v[72:75], v251 offset:20480
    s_mov_b32 s95, 0xc1a00000
    s_waitcnt lgkmcnt(4)
    v_mfma_f32_32x32x16_bf16 v[120:135], v[60:63], v[48:51], v[120:135]
    ds_read_b64_tr_b16 v[80:81], v32 offset:45056
    ds_read_b64_tr_b16 v[82:83], v32 offset:45568
    s_mov_b32 s96, 0x3f000000
    v_mfma_f32_32x32x16_bf16 v[136:151], v[60:63], v[52:55], v[136:151]
    ds_read_b64_tr_b16 v[84:85], v32 offset:47104
    ds_read_b64_tr_b16 v[86:87], v32 offset:47616
    s_mov_b32 s97, 0x3f000000
    v_mfma_f32_32x32x16_bf16 v[152:167], v[64:67], v[48:51], v[152:167]
    s_mov_b32 s98, 0x2b800000
    v_mfma_f32_32x32x16_bf16 v[168:183], v[64:67], v[52:55], v[168:183]
    s_mov_b32 s99, 0x2b800000
    s_waitcnt vmcnt(10) lgkmcnt(0)
    s_barrier
    v_mfma_f32_32x32x16_bf16 v[88:103], v[76:79], v[68:71], v[88:103]
    ds_read_b128 v[48:51], v248 offset:32768
    ds_read_b64_tr_b16 v[56:57], v33 offset:0
    v_lshrrev_b32 v4, 3, v1
    v_mul_u32_u24 v4, 896, v4
    v_mfma_f32_32x32x16_bf16 v[104:119], v[76:79], v[72:75], v[104:119]
    ds_read_b64_tr_b16 v[58:59], v33 offset:512
    ds_read_b128 v[52:55], v248 offset:36864
    v_bfe_u32 v5, v1, 4, 1
    v_lshlrev_b32 v5, 2, v5
    v_mfma_f32_32x32x16_bf16 v[120:135], v[80:83], v[68:71], v[120:135]
    ds_read_b64_tr_b16 v[60:61], v33 offset:2048
    ds_read_b64_tr_b16 v[62:63], v33 offset:2560
    v_and_b32 v6, 7, v1
    v_xor_b32 v5, v5, v6
    v_mfma_f32_32x32x16_bf16 v[136:151], v[80:83], v[72:75], v[136:151]
    ds_read_b64_tr_b16 v[64:65], v33 offset:4096
    ds_read_b64_tr_b16 v[66:67], v33 offset:4608
    s_lshl_b32 s87, s78, 7
    v_lshl_add_u32 v12, v5, 4, v4
    v_mfma_f32_32x32x16_bf16 v[152:167], v[84:87], v[68:71], v[152:167]
    v_add_u32 v12, s87, v12
    v_add_u32 v13, 6144, v12
    v_mfma_f32_32x32x16_bf16 v[168:183], v[84:87], v[72:75], v[168:183]
    v_add_u32 v14, 12288, v12
    s_waitcnt lgkmcnt(4)
    s_nop 0
    v_mfma_f32_32x32x16_bf16 v[88:103], v[56:59], v[48:51], v[88:103]
    ds_read_b128 v[68:71], v249 offset:32768
    ds_read_b64_tr_b16 v[76:77], v33 offset:6144
    v_add_u32 v15, 18432, v12
    s_mul_i32 s73, s70, 401408
    v_mfma_f32_32x32x16_bf16 v[104:119], v[56:59], v[52:55], v[104:119]
    ds_read_b64_tr_b16 v[78:79], v33 offset:6656
    ds_read_b128 v[72:75], v249 offset:36864
    s_mul_i32 s75, s70, 100352
    s_mul_i32 s74, s70, 20480
    s_waitcnt lgkmcnt(4)
    v_mfma_f32_32x32x16_bf16 v[120:135], v[60:63], v[48:51], v[120:135]
    buffer_load_dwordx4 v[184:187], v18, s[44:47], s65 offen offset:0 sc1
    ds_read_b64_tr_b16 v[80:81], v33 offset:8192
    ds_read_b64_tr_b16 v[82:83], v33 offset:8704
    s_add_u32 s74, s74, 61440
    s_lshl_b32 s20, s70, 14
    v_mfma_f32_32x32x16_bf16 v[136:151], v[60:63], v[52:55], v[136:151]
    buffer_load_dwordx4 v[188:191], v18, s[44:47], s65 offen offset:512 sc1
    ds_read_b64_tr_b16 v[84:85], v33 offset:10240
    ds_read_b64_tr_b16 v[86:87], v33 offset:10752
    s_add_u32 s20, s20, 20480
    s_cmp_eq_u32 s70, 0
    s_cselect_b32 s74, 16384, s74
    s_cselect_b32 s20, 0, s20
    v_mfma_f32_32x32x16_bf16 v[152:167], v[64:67], v[48:51], v[152:167]
    buffer_load_dwordx4 v[196:199], v26, s[44:47], s13 offen sc1
    s_cmp_eq_u32 s70, 3
    s_cselect_b32 s20, 143360, s20
    s_mul_i32 s87, s77, 286720
    v_mfma_f32_32x32x16_bf16 v[168:183], v[64:67], v[52:55], v[168:183]
    buffer_load_dwordx4 v[200:203], v26, s[44:47], s14 offen sc1
    s_mul_i32 s88, s70, 7168
    s_waitcnt lgkmcnt(4)
    v_mfma_f32_32x32x16_bf16 v[88:103], v[76:79], v[68:71], v[88:103]
    ds_read_b128 v[48:51], v250 offset:32768
    ds_read_b64_tr_b16 v[56:57], v33 offset:12288
    s_add_u32 s48, s87, s88
    s_add_u32 s49, s48, 143360
    v_mfma_f32_32x32x16_bf16 v[104:119], v[76:79], v[72:75], v[104:119]
    ds_read_b64_tr_b16 v[58:59], v33 offset:12800
    ds_read_b128 v[52:55], v250 offset:36864
    s_lshl2_add_u32 s87, s88, s87
    s_add_u32 s32, s87, 28672
    s_waitcnt lgkmcnt(4)
    s_nop 0
    v_mfma_f32_32x32x16_bf16 v[120:135], v[80:83], v[68:71], v[120:135]
    buffer_load_dwordx4 v[204:207], v26, s[44:47], s15 offen sc1
    ds_read_b64_tr_b16 v[60:61], v33 offset:14336
    ds_read_b64_tr_b16 v[62:63], v33 offset:14848
    s_add_u32 s39, s87, 172032
    s_add_u32 s33, s87, 32768
    v_mfma_f32_32x32x16_bf16 v[136:151], v[80:83], v[72:75], v[136:151]
    buffer_load_dwordx4 v[208:211], v26, s[44:47], s16 offen sc1
    ds_read_b64_tr_b16 v[64:65], v33 offset:16384
    ds_read_b64_tr_b16 v[66:67], v33 offset:16896
    s_add_u32 s21, s87, 176128
    s_add_u32 s34, s87, 36864
    v_mfma_f32_32x32x16_bf16 v[152:167], v[84:87], v[68:71], v[152:167]
    buffer_load_dwordx4 v[212:215], v26, s[44:47], s17 offen sc1
    s_add_u32 s24, s87, 180224
    s_add_u32 s35, s87, 40960
    v_mfma_f32_32x32x16_bf16 v[168:183], v[84:87], v[72:75], v[168:183]
    buffer_load_dwordx4 v[216:219], v26, s[44:47], s18 offen sc1
    s_add_u32 s25, s87, 184320
    s_waitcnt lgkmcnt(4)
    s_nop 0
    v_mfma_f32_32x32x16_bf16 v[88:103], v[56:59], v[48:51], v[88:103]
    ds_read_b128 v[68:71], v251 offset:32768
    ds_read_b64_tr_b16 v[76:77], v33 offset:18432
    s_add_u32 s36, s87, 45056
    s_add_u32 s72, s87, 188416
    s_add_u32 s37, s87, 49152
    v_mfma_f32_32x32x16_bf16 v[104:119], v[56:59], v[52:55], v[104:119]
    ds_read_b64_tr_b16 v[78:79], v33 offset:18944
    ds_read_b128 v[72:75], v251 offset:36864
    s_add_u32 s83, s87, 192512
    s_add_u32 s38, s87, 53248
    s_waitcnt lgkmcnt(4)
    s_nop 0
    v_mfma_f32_32x32x16_bf16 v[120:135], v[60:63], v[48:51], v[120:135]
    buffer_load_dwordx4 v[220:223], v26, s[44:47], s19 offen sc1
    ds_read_b64_tr_b16 v[80:81], v33 offset:20480
    ds_read_b64_tr_b16 v[82:83], v33 offset:20992
    s_add_u32 s85, s87, 196608
    s_mul_i32 s50, s70, 14336
    v_mfma_f32_32x32x16_bf16 v[136:151], v[60:63], v[52:55], v[136:151]
    ds_read_b64_tr_b16 v[84:85], v33 offset:22528
    ds_read_b64_tr_b16 v[86:87], v33 offset:23040
    s_add_u32 s50, s50, 9437184
    s_lshr_b32 s87, s77, 1
    v_mfma_f32_32x32x16_bf16 v[152:167], v[64:67], v[48:51], v[152:167]
    s_lshl_b32 s88, s87, 8
    s_add_u32 s43, s88, 9568256
    v_mfma_f32_32x32x16_bf16 v[168:183], v[64:67], v[52:55], v[168:183]
    s_add_u32 s51, s88, 9572352
    s_getpc_b64 s[10:11]
L_c2q:
    s_mul_i32 s12, s70, 2560
    v_min_u32 v255, 19, v1
    v_lshl_add_u32 v255, v255, 7, s12
    v_min_u32 v255, L_end-L_c2q-4, v255
    global_load_dword v254, v255, s[10:11]
    s_waitcnt vmcnt(10) lgkmcnt(0)
    s_barrier
    v_mfma_f32_32x32x16_bf16 v[88:103], v[76:79], v[68:71], v[88:103]
    ds_read_b128 v[48:51], v248 offset:0
    ds_read_b64_tr_b16 v[56:57], v32 offset:0
    v_lshrrev_b32 v4, 5, v1
    v_bfe_u32 v5, v1, 2, 2
    v_mfma_f32_32x32x16_bf16 v[104:119], v[76:79], v[72:75], v[104:119]
    ds_read_b64_tr_b16 v[58:59], v32 offset:512
    ds_read_b128 v[52:55], v248 offset:4096
    v_lshl_add_u32 v6, v4, 2, v5
    v_mfma_f32_32x32x16_bf16 v[120:135], v[80:83], v[68:71], v[120:135]
    s_add_u32 m0, s74, 0
    s_add_u32 s76, s73, 0
    buffer_load_dwordx4 v12, s[52:55], s76 offen offset:0 lds
    ds_read_b64_tr_b16 v[60:61], v32 offset:2048
    ds_read_b64_tr_b16 v[62:63], v32 offset:2560
    v_bfe_u32 v7, v1, 4, 1
    v_mfma_f32_32x32x16_bf16 v[136:151], v[80:83], v[72:75], v[136:151]
    buffer_load_dwordx4 v13, s[52:55], s76 offen offset:1024 lds
    ds_read_b64_tr_b16 v[64:65], v32 offset:4096
    ds_read_b64_tr_b16 v[66:67], v32 offset:4608
    v_lshlrev_b32 v7, 5, v7
    v_mfma_f32_32x32x16_bf16 v[152:167], v[84:87], v[68:71], v[152:167]
    buffer_load_dwordx4 v14, s[52:55], s76 offen offset:2048 lds
    v_and_b32 v4, 3, v1
    v_mfma_f32_32x32x16_bf16 v[168:183], v[84:87], v[72:75], v[168:183]
    buffer_load_dwordx4 v15, s[52:55], s76 offen offset:3072 lds
    v_lshl_add_u32 v7, v4, 3, v7
    s_waitcnt lgkmcnt(4)
    v_mfma_f32_32x32x16_bf16 v[88:103], v[56:59], v[48:51], v[88:103]
    ds_read_b128 v[68:71], v249 offset:0
    ds_read_b64_tr_b16 v[76:77], v32 offset:6144
    v_bfe_u32 v4, v1, 3, 1
    v_lshlrev_b32 v4, 6, v4
    v_mfma_f32_32x32x16_bf16 v[104:119], v[56:59], v[52:55], v[104:119]
    ds_read_b64_tr_b16 v[78:79], v32 offset:6656
    ds_read_b128 v[72:75], v249 offset:4096
    v_xor_b32 v4, v7, v4
    s_waitcnt lgkmcnt(4)
    s_nop 0
    v_mfma_f32_32x32x16_bf16 v[120:135], v[60:63], v[48:51], v[120:135]
    s_add_u32 m0, s74, 4096
    s_add_u32 s76, s73, 28672
    buffer_load_dwordx4 v12, s[52:55], s76 offen offset:0 lds
    ds_read_b64_tr_b16 v[80:81], v32 offset:8192
    ds_read_b64_tr_b16 v[82:83], v32 offset:8704
    v_lshl_add_u32 v4, v6, 7, v4
    v_mfma_f32_32x32x16_bf16 v[136:151], v[60:63], v[52:55], v[136:151]
    buffer_load_dwordx4 v13, s[52:55], s76 offen offset:1024 lds
    ds_read_b64_tr_b16 v[84:85], v32 offset:10240
    ds_read_b64_tr_b16 v[86:87], v32 offset:10752
    v_add_u32 v252, s74, v4
    v_xor_b32 v253, 64, v252
    v_mfma_f32_32x32x16_bf16 v[152:167], v[64:67], v[48:51], v[152:167]
    buffer_load_dwordx4 v14, s[52:55], s76 offen offset:2048 lds
    v_add_u32 v16, s20, v4
    v_mfma_f32_32x32x16_bf16 v[168:183], v[64:67], v[52:55], v[168:183]
    buffer_load_dwordx4 v15, s[52:55], s76 offen offset:3072 lds
    v_xor_b32 v17, 64, v16
    s_waitcnt lgkmcnt(4)
    v_mfma_f32_32x32x16_bf16 v[88:103], v[76:79], v[68:71], v[88:103]
    ds_read_b128 v[48:51], v250 offset:0
    ds_read_b64_tr_b16 v[56:57], v32 offset:12288
    v_mfma_f32_32x32x16_bf16 v[104:119], v[76:79], v[72:75], v[104:119]
    ds_read_b64_tr_b16 v[58:59], v32 offset:12800
    ds_read_b128 v[52:55], v250 offset:4096
    s_waitcnt lgkmcnt(4)
    v_mfma_f32_32x32x16_bf16 v[120:135], v[80:83], v[68:71], v[120:135]
    s_add_u32 m0, s74, 8192
    s_add_u32 s76, s73, 57344
    buffer_load_dwordx4 v12, s[52:55], s76 offen offset:0 lds
    ds_read_b64_tr_b16 v[60:61], v32 offset:14336
    ds_read_b64_tr_b16 v[62:63], v32 offset:14848
    v_mfma_f32_32x32x16_bf16 v[136:151], v[80:83], v[72:75], v[136:151]
    buffer_load_dwordx4 v13, s[52:55], s76 offen offset:1024 lds
    ds_read_b64_tr_b16 v[64:65], v32 offset:16384
    ds_read_b64_tr_b16 v[66:67], v32 offset:16896
    v_mfma_f32_32x32x16_bf16 v[152:167], v[84:87], v[68:71], v[152:167]
    buffer_load_dwordx4 v14, s[52:55], s76 offen offset:2048 lds
    v_mfma_f32_32x32x16_bf16 v[168:183], v[84:87], v[72:75], v[168:183]
    buffer_load_dwordx4 v15, s[52:55], s76 offen offset:3072 lds
    s_waitcnt lgkmcnt(4)
    v_mfma_f32_32x32x16_bf16 v[88:103], v[56:59], v[48:51], v[88:103]
    ds_read_b128 v[68:71], v251 offset:0
    ds_read_b64_tr_b16 v[76:77], v32 offset:18432
    s_waitcnt vmcnt(13)
    v_xor_b32 v224, s3, v185
    v_xor_b32 v225, s3, v187
    v_or_b32 v224, v224, v225
    v_xor_b32 v225, s3, v189
    v_mfma_f32_32x32x16_bf16 v[104:119], v[56:59], v[52:55], v[104:119]
    ds_read_b64_tr_b16 v[78:79], v32 offset:18944
    ds_read_b128 v[72:75], v251 offset:4096
    v_or_b32 v224, v224, v225
    v_xor_b32 v225, s3, v191
    v_or_b32 v224, v224, v225
    v_xor_b32 v225, s3, v197
    v_or_b32 v224, v224, v225
    s_waitcnt lgkmcnt(4)
    v_mfma_f32_32x32x16_bf16 v[120:135], v[60:63], v[48:51], v[120:135]
    ds_read_b64_tr_b16 v[80:81], v32 offset:20480
    ds_read_b64_tr_b16 v[82:83], v32 offset:20992
    v_xor_b32 v225, s3, v199
    v_or_b32 v224, v224, v225
    v_xor_b32 v225, s3, v201
    v_or_b32 v224, v224, v225
    v_xor_b32 v225, s3, v203
    v_mfma_f32_32x32x16_bf16 v[136:151], v[60:63], v[52:55], v[136:151]
    ds_read_b64_tr_b16 v[84:85], v32 offset:22528
    ds_read_b64_tr_b16 v[86:87], v32 offset:23040
    v_or_b32 v224, v224, v225
    v_xor_b32 v225, s3, v205
    v_or_b32 v224, v224, v225
    v_xor_b32 v225, s3, v207
    v_or_b32 v224, v224, v225
    v_mfma_f32_32x32x16_bf16 v[152:167], v[64:67], v[48:51], v[152:167]
    v_xor_b32 v225, s3, v209
    v_or_b32 v224, v224, v225
    v_xor_b32 v225, s3, v211
    v_or_b32 v224, v224, v225
    v_xor_b32 v225, s3, v213
    v_mfma_f32_32x32x16_bf16 v[168:183], v[64:67], v[52:55], v[168:183]
    v_or_b32 v224, v224, v225
    v_xor_b32 v225, s3, v215
    v_or_b32 v224, v224, v225
    v_xor_b32 v225, s3, v217
    v_or_b32 v224, v224, v225
    s_waitcnt lgkmcnt(4)
    v_mfma_f32_32x32x16_bf16 v[88:103], v[76:79], v[68:71], v[88:103]
    v_xor_b32 v225, s3, v219
    v_or_b32 v224, v224, v225
    v_xor_b32 v225, s3, v221
    v_or_b32 v224, v224, v225
    v_xor_b32 v225, s3, v223
    v_mfma_f32_32x32x16_bf16 v[104:119], v[76:79], v[72:75], v[104:119]
    v_or_b32 v224, v224, v225
    v_add_f32 v196, v196, v198
    v_add_f32 v200, v200, v202
    v_add_f32 v204, v204, v206
    v_add_f32 v208, v208, v210
    s_waitcnt lgkmcnt(0)
    v_mfma_f32_32x32x16_bf16 v[120:135], v[80:83], v[68:71], v[120:135]
    v_add_f32 v212, v212, v214
    v_add_f32 v216, v216, v218
    v_add_f32 v220, v220, v222
    v_add_f32 v196, v196, v200
    v_add_f32 v196, v196, v204
    v_mfma_f32_32x32x16_bf16 v[136:151], v[80:83], v[72:75], v[136:151]
    v_add_f32 v196, v196, v208
    v_add_f32 v196, v196, v212
    v_add_f32 v196, v196, v216
    v_add_f32 v196, v196, v220
    v_lshrrev_b32 v4, 2, v26
    v_mfma_f32_32x32x16_bf16 v[152:167], v[84:87], v[68:71], v[152:167]
    v_add_u32 v4, 159744, v4
    ds_write_b32 v4, v196
    v_mul_f32 v192, 0x3fb8aa3b, v184
    v_mul_f32 v228, 0x3fb8aa3b, v186
    v_mul_f32 v229, 0x3fb8aa3b, v186
    v_mfma_f32_32x32x16_bf16 v[168:183], v[84:87], v[72:75], v[168:183]
    v_mov_b32 v187, v186
    v_mul_f32 v194, 0x3fb8aa3b, v188
    v_mul_f32 v230, 0x3fb8aa3b, v190
    v_mul_f32 v231, 0x3fb8aa3b, v190
    v_mov_b32 v191, v190
    s_mov_b32 s92, 30000
ST_4:
    v_cmp_eq_u32 vcc, 0, v224
    s_nop 0
    s_cmp_eq_u64 vcc, -1
    s_cbranch_scc1 SK_5
    s_sub_u32 s92, s92, 1
    s_cmp_eq_u32 s92, 0
    s_cbranch_scc1 SK_5
    buffer_load_dwordx4 v[184:187], v18, s[44:47], s65 offen offset:0 sc1
    buffer_load_dwordx4 v[188:191], v18, s[44:47], s65 offen offset:512 sc1
    buffer_load_dwordx4 v[196:199], v26, s[44:47], s13 offen sc1
    buffer_load_dwordx4 v[200:203], v26, s[44:47], s14 offen sc1
    buffer_load_dwordx4 v[204:207], v26, s[44:47], s15 offen sc1
    buffer_load_dwordx4 v[208:211], v26, s[44:47], s16 offen sc1
    buffer_load_dwordx4 v[212:215], v26, s[44:47], s17 offen sc1
    buffer_load_dwordx4 v[216:219], v26, s[44:47], s18 offen sc1
    buffer_load_dwordx4 v[220:223], v26, s[44:47], s19 offen sc1
    s_waitcnt vmcnt(0)
    v_xor_b32 v224, s3, v185
    v_xor_b32 v225, s3, v187
    v_or_b32 v224, v224, v225
    v_xor_b32 v225, s3, v189
    v_or_b32 v224, v224, v225
    v_xor_b32 v225, s3, v191
    v_or_b32 v224, v224, v225
    v_xor_b32 v225, s3, v197
    v_or_b32 v224, v224, v225
    v_xor_b32 v225, s3, v199
    v_or_b32 v224, v224, v225
    v_xor_b32 v225, s3, v201
    v_or_b32 v224, v224, v225
    v_xor_b32 v225, s3, v203
    v_or_b32 v224, v224, v225
    v_xor_b32 v225, s3, v205
    v_or_b32 v224, v224, v225
    v_xor_b32 v225, s3, v207
    v_or_b32 v224, v224, v225
    v_xor_b32 v225, s3, v209
    v_or_b32 v224, v224, v225
    v_xor_b32 v225, s3, v211
    v_or_b32 v224, v224, v225
    v_xor_b32 v225, s3, v213
    v_or_b32 v224, v224, v225
    v_xor_b32 v225, s3, v215
    v_or_b32 v224, v224, v225
    v_xor_b32 v225, s3, v217
    v_or_b32 v224, v224, v225
    v_xor_b32 v225, s3, v219
    v_or_b32 v224, v224, v225
    v_xor_b32 v225, s3, v221
    v_or_b32 v224, v224, v225
    v_xor_b32 v225, s3, v223
    v_or_b32 v224, v224, v225
    v_add_f32 v196, v196, v198
    v_add_f32 v200, v200, v202
    v_add_f32 v204, v204, v206
    v_add_f32 v208, v208, v210
    v_add_f32 v212, v212, v214
    v_add_f32 v216, v216, v218
    v_add_f32 v220, v220, v222
    v_add_f32 v196, v196, v200
    v_add_f32 v196, v196, v204
    v_add_f32 v196, v196, v208
    v_add_f32 v196, v196, v212
    v_add_f32 v196, v196, v216
    v_add_f32 v196, v196, v220
    v_lshrrev_b32 v4, 2, v26
    v_add_u32 v4, 159744, v4
    ds_write_b32 v4, v196
    v_mul_f32 v192, 0x3fb8aa3b, v184
    v_mul_f32 v228, 0x3fb8aa3b, v186
    v_mul_f32 v229, 0x3fb8aa3b, v186
    v_mov_b32 v187, v186
    v_mul_f32 v194, 0x3fb8aa3b, v188
    v_mul_f32 v230, 0x3fb8aa3b, v190
    v_mul_f32 v231, 0x3fb8aa3b, v190
    v_mov_b32 v191, v190
    s_branch ST_4
SK_5:
    ds_read_b128 v[212:215], v35 offset:1024
    ds_read_b128 v[216:219], v35 offset:1056
    ds_read_b128 v[220:223], v35 offset:1088
    ds_read_b128 v[224:227], v35 offset:1120
    s_waitcnt lgkmcnt(0)
    s_barrier
    ds_read_b128 v[196:199], v35 offset:0
    ds_read_b128 v[200:203], v35 offset:32
    ds_read_b128 v[204:207], v35 offset:64
    ds_read_b128 v[208:211], v35 offset:96
    s_waitcnt lgkmcnt(0)
    s_nop 0
    v_pk_fma_f32 v[20:21], v[196:197], v[228:229], v[212:213]
    v_pk_fma_f32 v[24:25], v[198:199], v[228:229], v[214:215]
    v_pk_fma_f32 v[88:89], v[88:89], v[192:193], v[20:21] op_sel_hi:[1,0,1]
    v_pk_fma_f32 v[90:91], v[90:91], v[192:193], v[24:25] op_sel_hi:[1,0,1]
    v_pk_add_f32 v[20:21], v[88:89], s[94:95]
    s_add_u32 m0, s74, 12288
    s_add_u32 s76, s73, 86016
    buffer_load_dwordx4 v12, s[52:55], s76 offen offset:0 lds
    buffer_load_dwordx4 v13, s[52:55], s76 offen offset:1024 lds
    buffer_load_dwordx4 v14, s[52:55], s76 offen offset:2048 lds
    v_pk_add_f32 v[24:25], v[90:91], s[94:95]
    v_exp_f32 v20, v20 clamp
    v_exp_f32 v21, v21 clamp
    v_exp_f32 v24, v24 clamp
    v_exp_f32 v25, v25 clamp
    v_pk_fma_f32 v[22:23], v[20:21], s[96:97], v[30:31]
    v_pk_fma_f32 v[26:27], v[24:25], s[96:97], v[30:31]
    v_pk_mul_f32 v[20:21], v[20:21], v[22:23]
    v_pk_mul_f32 v[24:25], v[24:25], v[26:27]
    v_pk_add_f32 v[22:23], v[20:21], s[98:99]
    v_pk_add_f32 v[26:27], v[24:25], s[98:99]
    v_rcp_f32 v22, v22
    v_rcp_f32 v23, v23
    v_rcp_f32 v26, v26
    v_rcp_f32 v27, v27
    v_pk_mul_f32 v[20:21], v[88:89], v[20:21]
    v_pk_mul_f32 v[24:25], v[90:91], v[24:25]
    v_pk_mul_f32 v[20:21], v[20:21], v[22:23]
    v_pk_mul_f32 v[24:25], v[24:25], v[26:27]
    v_cvt_pk_bf16_f32 v232, v20, v21
    v_cvt_pk_bf16_f32 v233, v24, v25
    v_pk_fma_f32 v[20:21], v[200:201], v[228:229], v[216:217]
    v_pk_fma_f32 v[24:25], v[202:203], v[228:229], v[218:219]
    v_pk_fma_f32 v[92:93], v[92:93], v[192:193], v[20:21] op_sel_hi:[1,0,1]
    v_pk_fma_f32 v[94:95], v[94:95], v[192:193], v[24:25] op_sel_hi:[1,0,1]
    v_pk_add_f32 v[20:21], v[92:93], s[94:95]
    v_pk_add_f32 v[24:25], v[94:95], s[94:95]
    v_exp_f32 v20, v20 clamp
    v_exp_f32 v21, v21 clamp
    v_exp_f32 v24, v24 clamp
    v_exp_f32 v25, v25 clamp
    v_pk_fma_f32 v[22:23], v[20:21], s[96:97], v[30:31]
    v_pk_fma_f32 v[26:27], v[24:25], s[96:97], v[30:31]
    v_pk_mul_f32 v[20:21], v[20:21], v[22:23]
    v_pk_mul_f32 v[24:25], v[24:25], v[26:27]
    v_pk_add_f32 v[22:23], v[20:21], s[98:99]
    v_pk_add_f32 v[26:27], v[24:25], s[98:99]
    v_rcp_f32 v22, v22
    v_rcp_f32 v23, v23
    v_rcp_f32 v26, v26
    v_rcp_f32 v27, v27
    v_pk_mul_f32 v[20:21], v[92:93], v[20:21]
    v_pk_mul_f32 v[24:25], v[94:95], v[24:25]
    v_pk_mul_f32 v[20:21], v[20:21], v[22:23]
    v_pk_mul_f32 v[24:25], v[24:25], v[26:27]
    v_cvt_pk_bf16_f32 v234, v20, v21
    buffer_load_dwordx4 v15, s[52:55], s76 offen offset:3072 lds
    s_add_u32 m0, s74, 16384
    s_add_u32 s76, s73, 114688
    buffer_load_dwordx4 v12, s[52:55], s76 offen offset:0 lds
    buffer_load_dwordx4 v13, s[52:55], s76 offen offset:1024 lds
    v_cvt_pk_bf16_f32 v235, v24, v25
    v_pk_fma_f32 v[20:21], v[204:205], v[228:229], v[220:221]
    v_pk_fma_f32 v[24:25], v[206:207], v[228:229], v[222:223]
    v_pk_fma_f32 v[96:97], v[96:97], v[192:193], v[20:21] op_sel_hi:[1,0,1]
    v_pk_fma_f32 v[98:99], v[98:99], v[192:193], v[24:25] op_sel_hi:[1,0,1]
    v_pk_add_f32 v[20:21], v[96:97], s[94:95]
    v_pk_add_f32 v[24:25], v[98:99], s[94:95]
    v_exp_f32 v20, v20 clamp
    v_exp_f32 v21, v21 clamp
    v_exp_f32 v24, v24 clamp
    v_exp_f32 v25, v25 clamp
    v_pk_fma_f32 v[22:23], v[20:21], s[96:97], v[30:31]
    v_pk_fma_f32 v[26:27], v[24:25], s[96:97], v[30:31]
    v_pk_mul_f32 v[20:21], v[20:21], v[22:23]
    v_pk_mul_f32 v[24:25], v[24:25], v[26:27]
    v_pk_add_f32 v[22:23], v[20:21], s[98:99]
    v_pk_add_f32 v[26:27], v[24:25], s[98:99]
    v_rcp_f32 v22, v22
    v_rcp_f32 v23, v23
    v_rcp_f32 v26, v26
    v_rcp_f32 v27, v27
    v_pk_mul_f32 v[20:21], v[96:97], v[20:21]
    v_pk_mul_f32 v[24:25], v[98:99], v[24:25]
    v_pk_mul_f32 v[20:21], v[20:21], v[22:23]
    v_pk_mul_f32 v[24:25], v[24:25], v[26:27]
    v_cvt_pk_bf16_f32 v236, v20, v21
    v_cvt_pk_bf16_f32 v237, v24, v25
    v_pk_fma_f32 v[20:21], v[208:209], v[228:229], v[224:225]
    v_pk_fma_f32 v[24:25], v[210:211], v[228:229], v[226:227]
    v_pk_fma_f32 v[100:101], v[100:101], v[192:193], v[20:21] op_sel_hi:[1,0,1]
    v_pk_fma_f32 v[102:103], v[102:103], v[192:193], v[24:25] op_sel_hi:[1,0,1]
    v_pk_add_f32 v[20:21], v[100:101], s[94:95]
    v_pk_add_f32 v[24:25], v[102:103], s[94:95]
    v_exp_f32 v20, v20 clamp
    v_exp_f32 v21, v21 clamp
    v_exp_f32 v24, v24 clamp
    v_exp_f32 v25, v25 clamp
    v_pk_fma_f32 v[22:23], v[20:21], s[96:97], v[30:31]
    v_pk_fma_f32 v[26:27], v[24:25], s[96:97], v[30:31]
    v_pk_mul_f32 v[20:21], v[20:21], v[22:23]
    v_pk_mul_f32 v[24:25], v[24:25], v[26:27]
    v_pk_add_f32 v[22:23], v[20:21], s[98:99]
    v_pk_add_f32 v[26:27], v[24:25], s[98:99]
    v_rcp_f32 v22, v22
    v_rcp_f32 v23, v23
    v_rcp_f32 v26, v26
    v_rcp_f32 v27, v27
    v_pk_mul_f32 v[20:21], v[100:101], v[20:21]
    v_pk_mul_f32 v[24:25], v[102:103], v[24:25]
    v_pk_mul_f32 v[20:21], v[20:21], v[22:23]
    v_pk_mul_f32 v[24:25], v[24:25], v[26:27]
    v_cvt_pk_bf16_f32 v238, v20, v21
    v_cvt_pk_bf16_f32 v239, v24, v25
    s_add_u32 s87, s40, 0
    buffer_store_dwordx4 v[232:235], v34, s[44:47], s87 offen offset:0 sc1
    buffer_store_dwordx4 v[236:239], v34, s[44:47], s87 offen offset:1024 sc1
    v_pk_fma_f32 v[20:21], v[196:197], v[230:231], v[212:213]
    v_pk_fma_f32 v[24:25], v[198:199], v[230:231], v[214:215]
    v_pk_fma_f32 v[104:105], v[104:105], v[194:195], v[20:21] op_sel_hi:[1,0,1]
    v_pk_fma_f32 v[106:107], v[106:107], v[194:195], v[24:25] op_sel_hi:[1,0,1]
    v_pk_add_f32 v[20:21], v[104:105], s[94:95]
    buffer_load_dwordx4 v14, s[52:55], s76 offen offset:2048 lds
    buffer_load_dwordx4 v15, s[52:55], s76 offen offset:3072 lds
    s_add_u32 m0, s20, 0
    s_add_u32 s76, s73, 143360
    buffer_load_dwordx4 v12, s[52:55], s76 offen offset:0 lds
    v_pk_add_f32 v[24:25], v[106:107], s[94:95]
    v_exp_f32 v20, v20 clamp
    v_exp_f32 v21, v21 clamp
    v_exp_f32 v24, v24 clamp
    v_exp_f32 v25, v25 clamp
    v_pk_fma_f32 v[22:23], v[20:21], s[96:97], v[30:31]
    v_pk_fma_f32 v[26:27], v[24:25], s[96:97], v[30:31]
    v_pk_mul_f32 v[20:21], v[20:21], v[22:23]
    v_pk_mul_f32 v[24:25], v[24:25], v[26:27]
    v_pk_add_f32 v[22:23], v[20:21], s[98:99]
    v_pk_add_f32 v[26:27], v[24:25], s[98:99]
    v_rcp_f32 v22, v22
    v_rcp_f32 v23, v23
    v_rcp_f32 v26, v26
    v_rcp_f32 v27, v27
    v_pk_mul_f32 v[20:21], v[104:105], v[20:21]
    v_pk_mul_f32 v[24:25], v[106:107], v[24:25]
    v_pk_mul_f32 v[20:21], v[20:21], v[22:23]
    v_pk_mul_f32 v[24:25], v[24:25], v[26:27]
    v_cvt_pk_bf16_f32 v240, v20, v21
    v_cvt_pk_bf16_f32 v241, v24, v25
    v_pk_fma_f32 v[20:21], v[200:201], v[230:231], v[216:217]
    v_pk_fma_f32 v[24:25], v[202:203], v[230:231], v[218:219]
    v_pk_fma_f32 v[108:109], v[108:109], v[194:195], v[20:21] op_sel_hi:[1,0,1]
    v_pk_fma_f32 v[110:111], v[110:111], v[194:195], v[24:25] op_sel_hi:[1,0,1]
    v_pk_add_f32 v[20:21], v[108:109], s[94:95]
    v_pk_add_f32 v[24:25], v[110:111], s[94:95]
    v_exp_f32 v20, v20 clamp
    v_exp_f32 v21, v21 clamp
    v_exp_f32 v24, v24 clamp
    v_exp_f32 v25, v25 clamp
    ds_read_b128 v[40:43], v35 offset:256
    ds_read_b128 v[56:59], v35 offset:1280
    ds_read_b128 v[44:47], v35 offset:288
    ds_read_b128 v[60:63], v35 offset:1312
    ds_read_b128 v[48:51], v35 offset:320
    ds_read_b128 v[64:67], v35 offset:1344
    ds_read_b128 v[52:55], v35 offset:352
    ds_read_b128 v[68:71], v35 offset:1376
    v_pk_fma_f32 v[22:23], v[20:21], s[96:97], v[30:31]
    v_pk_fma_f32 v[26:27], v[24:25], s[96:97], v[30:31]
    v_pk_mul_f32 v[20:21], v[20:21], v[22:23]
    v_pk_mul_f32 v[24:25], v[24:25], v[26:27]
    v_pk_add_f32 v[22:23], v[20:21], s[98:99]
    v_pk_add_f32 v[26:27], v[24:25], s[98:99]
    v_rcp_f32 v22, v22
    v_rcp_f32 v23, v23
    v_rcp_f32 v26, v26
    v_rcp_f32 v27, v27
    v_pk_mul_f32 v[20:21], v[108:109], v[20:21]
    v_pk_mul_f32 v[24:25], v[110:111], v[24:25]
    v_pk_mul_f32 v[20:21], v[20:21], v[22:23]
    v_pk_mul_f32 v[24:25], v[24:25], v[26:27]
    v_cvt_pk_bf16_f32 v242, v20, v21
    v_cvt_pk_bf16_f32 v243, v24, v25
    v_pk_fma_f32 v[20:21], v[204:205], v[230:231], v[220:221]
    v_pk_fma_f32 v[24:25], v[206:207], v[230:231], v[222:223]
    v_pk_fma_f32 v[112:113], v[112:113], v[194:195], v[20:21] op_sel_hi:[1,0,1]
    v_pk_fma_f32 v[114:115], v[114:115], v[194:195], v[24:25] op_sel_hi:[1,0,1]
    v_pk_add_f32 v[20:21], v[112:113], s[94:95]
    v_pk_add_f32 v[24:25], v[114:115], s[94:95]
    v_exp_f32 v20, v20 clamp
    v_exp_f32 v21, v21 clamp
    v_exp_f32 v24, v24 clamp
    v_exp_f32 v25, v25 clamp
    v_pk_fma_f32 v[22:23], v[20:21], s[96:97], v[30:31]
    v_pk_fma_f32 v[26:27], v[24:25], s[96:97], v[30:31]
    v_pk_mul_f32 v[20:21], v[20:21], v[22:23]
    v_pk_mul_f32 v[24:25], v[24:25], v[26:27]
    v_pk_add_f32 v[22:23], v[20:21], s[98:99]
    buffer_load_dwordx4 v13, s[52:55], s76 offen offset:1024 lds
    buffer_load_dwordx4 v14, s[52:55], s76 offen offset:2048 lds
    buffer_load_dwordx4 v15, s[52:55], s76 offen offset:3072 lds
    v_pk_add_f32 v[26:27], v[24:25], s[98:99]
    v_rcp_f32 v22, v22
    v_rcp_f32 v23, v23
    v_rcp_f32 v26, v26
    v_rcp_f32 v27, v27
    v_pk_mul_f32 v[20:21], v[112:113], v[20:21]
    v_pk_mul_f32 v[24:25], v[114:115], v[24:25]
    v_pk_mul_f32 v[20:21], v[20:21], v[22:23]
    v_pk_mul_f32 v[24:25], v[24:25], v[26:27]
    v_cvt_pk_bf16_f32 v244, v20, v21
    v_cvt_pk_bf16_f32 v245, v24, v25
    v_pk_fma_f32 v[20:21], v[208:209], v[230:231], v[224:225]
    v_pk_fma_f32 v[24:25], v[210:211], v[230:231], v[226:227]
    v_pk_fma_f32 v[116:117], v[116:117], v[194:195], v[20:21] op_sel_hi:[1,0,1]
    v_pk_fma_f32 v[118:119], v[118:119], v[194:195], v[24:25] op_sel_hi:[1,0,1]
    v_pk_add_f32 v[20:21], v[116:117], s[94:95]
    v_pk_add_f32 v[24:25], v[118:119], s[94:95]
    v_exp_f32 v20, v20 clamp
    v_exp_f32 v21, v21 clamp
    v_exp_f32 v24, v24 clamp
    v_exp_f32 v25, v25 clamp
    v_pk_fma_f32 v[22:23], v[20:21], s[96:97], v[30:31]
    v_pk_fma_f32 v[26:27], v[24:25], s[96:97], v[30:31]
    v_pk_mul_f32 v[20:21], v[20:21], v[22:23]
    v_pk_mul_f32 v[24:25], v[24:25], v[26:27]
    v_pk_add_f32 v[22:23], v[20:21], s[98:99]
    v_pk_add_f32 v[26:27], v[24:25], s[98:99]
    v_rcp_f32 v22, v22
    v_rcp_f32 v23, v23
    v_rcp_f32 v26, v26
    v_rcp_f32 v27, v27
    v_pk_mul_f32 v[20:21], v[116:117], v[20:21]
    v_pk_mul_f32 v[24:25], v[118:119], v[24:25]
    v_pk_mul_f32 v[20:21], v[20:21], v[22:23]
    v_pk_mul_f32 v[24:25], v[24:25], v[26:27]
    v_cvt_pk_bf16_f32 v246, v20, v21
    v_cvt_pk_bf16_f32 v247, v24, v25
    s_add_u32 s87, s40, 143360
    buffer_store_dwordx4 v[240:243], v34, s[44:47], s87 offen offset:0 sc1
    buffer_store_dwordx4 v[244:247], v34, s[44:47], s87 offen offset:1024 sc1
    s_waitcnt lgkmcnt(0)
    s_nop 0
    v_pk_fma_f32 v[20:21], v[40:41], v[228:229], v[56:57]
    v_pk_fma_f32 v[24:25], v[42:43], v[228:229], v[58:59]
    v_pk_fma_f32 v[120:121], v[120:121], v[192:193], v[20:21] op_sel_hi:[1,0,1]
    v_pk_fma_f32 v[122:123], v[122:123], v[192:193], v[24:25] op_sel_hi:[1,0,1]
    v_pk_add_f32 v[20:21], v[120:121], s[94:95]
    s_add_u32 m0, s20, 4096
    s_add_u32 s76, s73, 172032
    buffer_load_dwordx4 v12, s[52:55], s76 offen offset:0 lds
    buffer_load_dwordx4 v13, s[52:55], s76 offen offset:1024 lds
    buffer_load_dwordx4 v14, s[52:55], s76 offen offset:2048 lds
    v_pk_add_f32 v[24:25], v[122:123], s[94:95]
    v_exp_f32 v20, v20 clamp
    v_exp_f32 v21, v21 clamp
    v_exp_f32 v24, v24 clamp
    v_exp_f32 v25, v25 clamp
    v_pk_fma_f32 v[22:23], v[20:21], s[96:97], v[30:31]
    v_pk_fma_f32 v[26:27], v[24:25], s[96:97], v[30:31]
    v_pk_mul_f32 v[20:21], v[20:21], v[22:23]
    v_pk_mul_f32 v[24:25], v[24:25], v[26:27]
    v_pk_add_f32 v[22:23], v[20:21], s[98:99]
    v_pk_add_f32 v[26:27], v[24:25], s[98:99]
    v_rcp_f32 v22, v22
    v_rcp_f32 v23, v23
    v_rcp_f32 v26, v26
    v_rcp_f32 v27, v27
    v_pk_mul_f32 v[20:21], v[120:121], v[20:21]
    v_pk_mul_f32 v[24:25], v[122:123], v[24:25]
    v_pk_mul_f32 v[20:21], v[20:21], v[22:23]
    v_pk_mul_f32 v[24:25], v[24:25], v[26:27]
    v_cvt_pk_bf16_f32 v232, v20, v21
    v_cvt_pk_bf16_f32 v233, v24, v25
    v_pk_fma_f32 v[20:21], v[44:45], v[228:229], v[60:61]
    v_pk_fma_f32 v[24:25], v[46:47], v[228:229], v[62:63]
    v_pk_fma_f32 v[124:125], v[124:125], v[192:193], v[20:21] op_sel_hi:[1,0,1]
    v_pk_fma_f32 v[126:127], v[126:127], v[192:193], v[24:25] op_sel_hi:[1,0,1]
    v_pk_add_f32 v[20:21], v[124:125], s[94:95]
    v_pk_add_f32 v[24:25], v[126:127], s[94:95]
    v_exp_f32 v20, v20 clamp
    v_exp_f32 v21, v21 clamp
    v_exp_f32 v24, v24 clamp
    v_exp_f32 v25, v25 clamp
    v_pk_fma_f32 v[22:23], v[20:21], s[96:97], v[30:31]
    v_pk_fma_f32 v[26:27], v[24:25], s[96:97], v[30:31]
    v_pk_mul_f32 v[20:21], v[20:21], v[22:23]
    v_pk_mul_f32 v[24:25], v[24:25], v[26:27]
    v_pk_add_f32 v[22:23], v[20:21], s[98:99]
    v_pk_add_f32 v[26:27], v[24:25], s[98:99]
    v_rcp_f32 v22, v22
    v_rcp_f32 v23, v23
    v_rcp_f32 v26, v26
    v_rcp_f32 v27, v27
    v_pk_mul_f32 v[20:21], v[124:125], v[20:21]
    v_pk_mul_f32 v[24:25], v[126:127], v[24:25]
    v_pk_mul_f32 v[20:21], v[20:21], v[22:23]
    v_pk_mul_f32 v[24:25], v[24:25], v[26:27]
    v_cvt_pk_bf16_f32 v234, v20, v21
    buffer_load_dwordx4 v15, s[52:55], s76 offen offset:3072 lds
    s_add_u32 m0, s20, 8192
    s_add_u32 s76, s73, 200704
    buffer_load_dwordx4 v12, s[52:55], s76 offen offset:0 lds
    buffer_load_dwordx4 v13, s[52:55], s76 offen offset:1024 lds
    v_cvt_pk_bf16_f32 v235, v24, v25
    v_pk_fma_f32 v[20:21], v[48:49], v[228:229], v[64:65]
    v_pk_fma_f32 v[24:25], v[50:51], v[228:229], v[66:67]
    v_pk_fma_f32 v[128:129], v[128:129], v[192:193], v[20:21] op_sel_hi:[1,0,1]
    v_pk_fma_f32 v[130:131], v[130:131], v[192:193], v[24:25] op_sel_hi:[1,0,1]
    v_pk_add_f32 v[20:21], v[128:129], s[94:95]
    v_pk_add_f32 v[24:25], v[130:131], s[94:95]
    v_exp_f32 v20, v20 clamp
    v_exp_f32 v21, v21 clamp
    v_exp_f32 v24, v24 clamp
    v_exp_f32 v25, v25 clamp
    v_pk_fma_f32 v[22:23], v[20:21], s[96:97], v[30:31]
    v_pk_fma_f32 v[26:27], v[24:25], s[96:97], v[30:31]
    v_pk_mul_f32 v[20:21], v[20:21], v[22:23]
    v_pk_mul_f32 v[24:25], v[24:25], v[26:27]
    v_pk_add_f32 v[22:23], v[20:21], s[98:99]
    v_pk_add_f32 v[26:27], v[24:25], s[98:99]
    v_rcp_f32 v22, v22
    v_rcp_f32 v23, v23
    v_rcp_f32 v26, v26
    v_rcp_f32 v27, v27
    v_pk_mul_f32 v[20:21], v[128:129], v[20:21]
    v_pk_mul_f32 v[24:25], v[130:131], v[24:25]
    v_pk_mul_f32 v[20:21], v[20:21], v[22:23]
    v_pk_mul_f32 v[24:25], v[24:25], v[26:27]
    v_cvt_pk_bf16_f32 v236, v20, v21
    v_cvt_pk_bf16_f32 v237, v24, v25
    v_pk_fma_f32 v[20:21], v[52:53], v[228:229], v[68:69]
    v_pk_fma_f32 v[24:25], v[54:55], v[228:229], v[70:71]
    v_pk_fma_f32 v[132:133], v[132:133], v[192:193], v[20:21] op_sel_hi:[1,0,1]
    v_pk_fma_f32 v[134:135], v[134:135], v[192:193], v[24:25] op_sel_hi:[1,0,1]
    v_pk_add_f32 v[20:21], v[132:133], s[94:95]
    v_pk_add_f32 v[24:25], v[134:135], s[94:95]
    v_exp_f32 v20, v20 clamp
    v_exp_f32 v21, v21 clamp
    v_exp_f32 v24, v24 clamp
    v_exp_f32 v25, v25 clamp
    v_pk_fma_f32 v[22:23], v[20:21], s[96:97], v[30:31]
    v_pk_fma_f32 v[26:27], v[24:25], s[96:97], v[30:31]
    v_pk_mul_f32 v[20:21], v[20:21], v[22:23]
    v_pk_mul_f32 v[24:25], v[24:25], v[26:27]
    v_pk_add_f32 v[22:23], v[20:21], s[98:99]
    v_pk_add_f32 v[26:27], v[24:25], s[98:99]
    v_rcp_f32 v22, v22
    v_rcp_f32 v23, v23
    v_rcp_f32 v26, v26
    v_rcp_f32 v27, v27
    v_pk_mul_f32 v[20:21], v[132:133], v[20:21]
    v_pk_mul_f32 v[24:25], v[134:135], v[24:25]
    v_pk_mul_f32 v[20:21], v[20:21], v[22:23]
    v_pk_mul_f32 v[24:25], v[24:25], v[26:27]
    v_cvt_pk_bf16_f32 v238, v20, v21
    v_cvt_pk_bf16_f32 v239, v24, v25
    s_add_u32 s87, s41, 0
    s_nop 0
    buffer_store_dwordx4 v[232:235], v34, s[44:47], s87 offen offset:0 sc1
    buffer_store_dwordx4 v[236:239], v34, s[44:47], s87 offen offset:1024 sc1
    v_pk_fma_f32 v[20:21], v[40:41], v[230:231], v[56:57]
    v_pk_fma_f32 v[24:25], v[42:43], v[230:231], v[58:59]
    v_pk_fma_f32 v[136:137], v[136:137], v[194:195], v[20:21] op_sel_hi:[1,0,1]
    v_pk_fma_f32 v[138:139], v[138:139], v[194:195], v[24:25] op_sel_hi:[1,0,1]
    v_pk_add_f32 v[20:21], v[136:137], s[94:95]
    buffer_load_dwordx4 v14, s[52:55], s76 offen offset:2048 lds
    buffer_load_dwordx4 v15, s[52:55], s76 offen offset:3072 lds
    s_add_u32 m0, s20, 12288
    s_add_u32 s76, s73, 229376
    buffer_load_dwordx4 v12, s[52:55], s76 offen offset:0 lds
    v_pk_add_f32 v[24:25], v[138:139], s[94:95]
    v_exp_f32 v20, v20 clamp
    v_exp_f32 v21, v21 clamp
    v_exp_f32 v24, v24 clamp
    v_exp_f32 v25, v25 clamp
    v_pk_fma_f32 v[22:23], v[20:21], s[96:97], v[30:31]
    v_pk_fma_f32 v[26:27], v[24:25], s[96:97], v[30:31]
    v_pk_mul_f32 v[20:21], v[20:21], v[22:23]
    v_pk_mul_f32 v[24:25], v[24:25], v[26:27]
    v_pk_add_f32 v[22:23], v[20:21], s[98:99]
    v_pk_add_f32 v[26:27], v[24:25], s[98:99]
    v_rcp_f32 v22, v22
    v_rcp_f32 v23, v23
    v_rcp_f32 v26, v26
    v_rcp_f32 v27, v27
    v_pk_mul_f32 v[20:21], v[136:137], v[20:21]
    v_pk_mul_f32 v[24:25], v[138:139], v[24:25]
    v_pk_mul_f32 v[20:21], v[20:21], v[22:23]
    v_pk_mul_f32 v[24:25], v[24:25], v[26:27]
    v_cvt_pk_bf16_f32 v240, v20, v21
    v_cvt_pk_bf16_f32 v241, v24, v25
    v_pk_fma_f32 v[20:21], v[44:45], v[230:231], v[60:61]
    v_pk_fma_f32 v[24:25], v[46:47], v[230:231], v[62:63]
    v_pk_fma_f32 v[140:141], v[140:141], v[194:195], v[20:21] op_sel_hi:[1,0,1]
    v_pk_fma_f32 v[142:143], v[142:143], v[194:195], v[24:25] op_sel_hi:[1,0,1]
    v_pk_add_f32 v[20:21], v[140:141], s[94:95]
    v_pk_add_f32 v[24:25], v[142:143], s[94:95]
    v_exp_f32 v20, v20 clamp
    v_exp_f32 v21, v21 clamp
    v_exp_f32 v24, v24 clamp
    v_exp_f32 v25, v25 clamp
    ds_read_b128 v[196:199], v35 offset:512
    ds_read_b128 v[212:215], v35 offset:1536
    ds_read_b128 v[200:203], v35 offset:544
    ds_read_b128 v[216:219], v35 offset:1568
    ds_read_b128 v[204:207], v35 offset:576
    ds_read_b128 v[220:223], v35 offset:1600
    ds_read_b128 v[208:211], v35 offset:608
    ds_read_b128 v[224:227], v35 offset:1632
    v_pk_fma_f32 v[22:23], v[20:21], s[96:97], v[30:31]
    v_pk_fma_f32 v[26:27], v[24:25], s[96:97], v[30:31]
    v_pk_mul_f32 v[20:21], v[20:21], v[22:23]
    v_pk_mul_f32 v[24:25], v[24:25], v[26:27]
    v_pk_add_f32 v[22:23], v[20:21], s[98:99]
    v_pk_add_f32 v[26:27], v[24:25], s[98:99]
    v_rcp_f32 v22, v22
    v_rcp_f32 v23, v23
    v_rcp_f32 v26, v26
    v_rcp_f32 v27, v27
    v_pk_mul_f32 v[20:21], v[140:141], v[20:21]
    v_pk_mul_f32 v[24:25], v[142:143], v[24:25]
    v_pk_mul_f32 v[20:21], v[20:21], v[22:23]
    v_pk_mul_f32 v[24:25], v[24:25], v[26:27]
    v_cvt_pk_bf16_f32 v242, v20, v21
    v_cvt_pk_bf16_f32 v243, v24, v25
    v_pk_fma_f32 v[20:21], v[48:49], v[230:231], v[64:65]
    v_pk_fma_f32 v[24:25], v[50:51], v[230:231], v[66:67]
    v_pk_fma_f32 v[144:145], v[144:145], v[194:195], v[20:21] op_sel_hi:[1,0,1]
    v_pk_fma_f32 v[146:147], v[146:147], v[194:195], v[24:25] op_sel_hi:[1,0,1]
    v_pk_add_f32 v[20:21], v[144:145], s[94:95]
    v_pk_add_f32 v[24:25], v[146:147], s[94:95]
    v_exp_f32 v20, v20 clamp
    v_exp_f32 v21, v21 clamp
    v_exp_f32 v24, v24 clamp
    v_exp_f32 v25, v25 clamp
    v_pk_fma_f32 v[22:23], v[20:21], s[96:97], v[30:31]
    v_pk_fma_f32 v[26:27], v[24:25], s[96:97], v[30:31]
    v_pk_mul_f32 v[20:21], v[20:21], v[22:23]
    v_pk_mul_f32 v[24:25], v[24:25], v[26:27]
    v_pk_add_f32 v[22:23], v[20:21], s[98:99]
    buffer_load_dwordx4 v13, s[52:55], s76 offen offset:1024 lds
    buffer_load_dwordx4 v14, s[52:55], s76 offen offset:2048 lds
    buffer_load_dwordx4 v15, s[52:55], s76 offen offset:3072 lds
    v_pk_add_f32 v[26:27], v[24:25], s[98:99]
    v_rcp_f32 v22, v22
    v_rcp_f32 v23, v23
    v_rcp_f32 v26, v26
    v_rcp_f32 v27, v27
    v_pk_mul_f32 v[20:21], v[144:145], v[20:21]
    v_pk_mul_f32 v[24:25], v[146:147], v[24:25]
    v_pk_mul_f32 v[20:21], v[20:21], v[22:23]
    v_pk_mul_f32 v[24:25], v[24:25], v[26:27]
    v_cvt_pk_bf16_f32 v244, v20, v21
    v_cvt_pk_bf16_f32 v245, v24, v25
    v_pk_fma_f32 v[20:21], v[52:53], v[230:231], v[68:69]
    v_pk_fma_f32 v[24:25], v[54:55], v[230:231], v[70:71]
    v_pk_fma_f32 v[148:149], v[148:149], v[194:195], v[20:21] op_sel_hi:[1,0,1]
    v_pk_fma_f32 v[150:151], v[150:151], v[194:195], v[24:25] op_sel_hi:[1,0,1]
    v_pk_add_f32 v[20:21], v[148:149], s[94:95]
    v_pk_add_f32 v[24:25], v[150:151], s[94:95]
    v_exp_f32 v20, v20 clamp
    v_exp_f32 v21, v21 clamp
    v_exp_f32 v24, v24 clamp
    v_exp_f32 v25, v25 clamp
    v_pk_fma_f32 v[22:23], v[20:21], s[96:97], v[30:31]
    v_pk_fma_f32 v[26:27], v[24:25], s[96:97], v[30:31]
    v_pk_mul_f32 v[20:21], v[20:21], v[22:23]
    v_pk_mul_f32 v[24:25], v[24:25], v[26:27]
    v_pk_add_f32 v[22:23], v[20:21], s[98:99]
    v_pk_add_f32 v[26:27], v[24:25], s[98:99]
    v_rcp_f32 v22, v22
    v_rcp_f32 v23, v23
    v_rcp_f32 v26, v26
    v_rcp_f32 v27, v27
    v_pk_mul_f32 v[20:21], v[148:149], v[20:21]
    v_pk_mul_f32 v[24:25], v[150:151], v[24:25]
    v_pk_mul_f32 v[20:21], v[20:21], v[22:23]
    v_pk_mul_f32 v[24:25], v[24:25], v[26:27]
    v_cvt_pk_bf16_f32 v246, v20, v21
    v_cvt_pk_bf16_f32 v247, v24, v25
    s_add_u32 s87, s41, 143360
    buffer_store_dwordx4 v[240:243], v34, s[44:47], s87 offen offset:0 sc1
    buffer_store_dwordx4 v[244:247], v34, s[44:47], s87 offen offset:1024 sc1
    s_waitcnt lgkmcnt(0)
    s_cmp_lg_u32 s80, 1
    s_cbranch_scc1 L_eq
    s_nop 0
    v_pk_fma_f32 v[20:21], v[196:197], v[228:229], v[212:213]
    v_pk_fma_f32 v[24:25], v[198:199], v[228:229], v[214:215]
    v_pk_fma_f32 v[152:153], v[152:153], v[192:193], v[20:21] op_sel_hi:[1,0,1]
    v_pk_fma_f32 v[154:155], v[154:155], v[192:193], v[24:25] op_sel_hi:[1,0,1]
    v_pk_add_f32 v[20:21], v[152:153], s[94:95]
    v_pk_add_f32 v[24:25], v[154:155], s[94:95]
    v_exp_f32 v20, v20 clamp
    v_exp_f32 v21, v21 clamp
    v_exp_f32 v24, v24 clamp
    v_exp_f32 v25, v25 clamp
    v_pk_fma_f32 v[22:23], v[20:21], s[96:97], v[30:31]
    v_pk_fma_f32 v[26:27], v[24:25], s[96:97], v[30:31]
    v_pk_mul_f32 v[20:21], v[20:21], v[22:23]
    v_pk_mul_f32 v[24:25], v[24:25], v[26:27]
    v_pk_add_f32 v[22:23], v[20:21], s[98:99]
    v_pk_add_f32 v[26:27], v[24:25], s[98:99]
    v_rcp_f32 v22, v22
    v_rcp_f32 v23, v23
    v_rcp_f32 v26, v26
    v_rcp_f32 v27, v27
    v_pk_mul_f32 v[20:21], v[152:153], v[20:21]
    v_pk_mul_f32 v[24:25], v[154:155], v[24:25]
    v_pk_mul_f32 v[20:21], v[20:21], v[22:23]
    v_pk_mul_f32 v[24:25], v[24:25], v[26:27]
    v_cvt_pk_bf16_f32 v232, v20, v21
    v_cvt_pk_bf16_f32 v233, v24, v25
    v_pk_fma_f32 v[20:21], v[200:201], v[228:229], v[216:217]
    v_pk_fma_f32 v[24:25], v[202:203], v[228:229], v[218:219]
    v_pk_fma_f32 v[156:157], v[156:157], v[192:193], v[20:21] op_sel_hi:[1,0,1]
    v_pk_fma_f32 v[158:159], v[158:159], v[192:193], v[24:25] op_sel_hi:[1,0,1]
    v_pk_add_f32 v[20:21], v[156:157], s[94:95]
    v_pk_add_f32 v[24:25], v[158:159], s[94:95]
    v_exp_f32 v20, v20 clamp
    v_exp_f32 v21, v21 clamp
    v_exp_f32 v24, v24 clamp
    v_exp_f32 v25, v25 clamp
    v_pk_fma_f32 v[22:23], v[20:21], s[96:97], v[30:31]
    v_pk_fma_f32 v[26:27], v[24:25], s[96:97], v[30:31]
    v_pk_mul_f32 v[20:21], v[20:21], v[22:23]
    v_pk_mul_f32 v[24:25], v[24:25], v[26:27]
    v_pk_add_f32 v[22:23], v[20:21], s[98:99]
    v_pk_add_f32 v[26:27], v[24:25], s[98:99]
    v_rcp_f32 v22, v22
    v_rcp_f32 v23, v23
    v_rcp_f32 v26, v26
    v_rcp_f32 v27, v27
    v_pk_mul_f32 v[20:21], v[156:157], v[20:21]
    v_pk_mul_f32 v[24:25], v[158:159], v[24:25]
    v_pk_mul_f32 v[20:21], v[20:21], v[22:23]
    v_pk_mul_f32 v[24:25], v[24:25], v[26:27]
    v_cvt_pk_bf16_f32 v234, v20, v21
    v_cvt_pk_bf16_f32 v235, v24, v25
    v_pk_fma_f32 v[20:21], v[204:205], v[228:229], v[220:221]
    v_pk_fma_f32 v[24:25], v[206:207], v[228:229], v[222:223]
    v_pk_fma_f32 v[160:161], v[160:161], v[192:193], v[20:21] op_sel_hi:[1,0,1]
    v_pk_fma_f32 v[162:163], v[162:163], v[192:193], v[24:25] op_sel_hi:[1,0,1]
    v_pk_add_f32 v[20:21], v[160:161], s[94:95]
    v_pk_add_f32 v[24:25], v[162:163], s[94:95]
    v_exp_f32 v20, v20 clamp
    v_exp_f32 v21, v21 clamp
    v_exp_f32 v24, v24 clamp
    v_exp_f32 v25, v25 clamp
    v_pk_fma_f32 v[22:23], v[20:21], s[96:97], v[30:31]
    v_pk_fma_f32 v[26:27], v[24:25], s[96:97], v[30:31]
    v_pk_mul_f32 v[20:21], v[20:21], v[22:23]
    v_pk_mul_f32 v[24:25], v[24:25], v[26:27]
    v_pk_add_f32 v[22:23], v[20:21], s[98:99]
    v_pk_add_f32 v[26:27], v[24:25], s[98:99]
    v_rcp_f32 v22, v22
    v_rcp_f32 v23, v23
    v_rcp_f32 v26, v26
    v_rcp_f32 v27, v27
    v_pk_mul_f32 v[20:21], v[160:161], v[20:21]
    v_pk_mul_f32 v[24:25], v[162:163], v[24:25]
    v_pk_mul_f32 v[20:21], v[20:21], v[22:23]
    v_pk_mul_f32 v[24:25], v[24:25], v[26:27]
    v_cvt_pk_bf16_f32 v236, v20, v21
    v_cvt_pk_bf16_f32 v237, v24, v25
    v_pk_fma_f32 v[20:21], v[208:209], v[228:229], v[224:225]
    v_pk_fma_f32 v[24:25], v[210:211], v[228:229], v[226:227]
    v_pk_fma_f32 v[164:165], v[164:165], v[192:193], v[20:21] op_sel_hi:[1,0,1]
    v_pk_fma_f32 v[166:167], v[166:167], v[192:193], v[24:25] op_sel_hi:[1,0,1]
    v_pk_add_f32 v[20:21], v[164:165], s[94:95]
    v_pk_add_f32 v[24:25], v[166:167], s[94:95]
    v_exp_f32 v20, v20 clamp
    v_exp_f32 v21, v21 clamp
    v_exp_f32 v24, v24 clamp
    v_exp_f32 v25, v25 clamp
    v_pk_fma_f32 v[22:23], v[20:21], s[96:97], v[30:31]
    v_pk_fma_f32 v[26:27], v[24:25], s[96:97], v[30:31]
    v_pk_mul_f32 v[20:21], v[20:21], v[22:23]
    v_pk_mul_f32 v[24:25], v[24:25], v[26:27]
    v_pk_add_f32 v[22:23], v[20:21], s[98:99]
    v_pk_add_f32 v[26:27], v[24:25], s[98:99]
    v_rcp_f32 v22, v22
    v_rcp_f32 v23, v23
    v_rcp_f32 v26, v26
    v_rcp_f32 v27, v27
    v_pk_mul_f32 v[20:21], v[164:165], v[20:21]
    v_pk_mul_f32 v[24:25], v[166:167], v[24:25]
    v_pk_mul_f32 v[20:21], v[20:21], v[22:23]
    v_pk_mul_f32 v[24:25], v[24:25], v[26:27]
    v_cvt_pk_bf16_f32 v238, v20, v21
    v_cvt_pk_bf16_f32 v239, v24, v25
    s_add_u32 s87, s42, 0
    s_nop 0
    buffer_store_dwordx4 v[232:235], v34, s[44:47], s87 offen offset:0 sc1
    buffer_store_dwordx4 v[236:239], v34, s[44:47], s87 offen offset:1024 sc1
    v_pk_fma_f32 v[20:21], v[196:197], v[230:231], v[212:213]
    v_pk_fma_f32 v[24:25], v[198:199], v[230:231], v[214:215]
    v_pk_fma_f32 v[168:169], v[168:169], v[194:195], v[20:21] op_sel_hi:[1,0,1]
    v_pk_fma_f32 v[170:171], v[170:171], v[194:195], v[24:25] op_sel_hi:[1,0,1]
    v_pk_add_f32 v[20:21], v[168:169], s[94:95]
    v_pk_add_f32 v[24:25], v[170:171], s[94:95]
    v_exp_f32 v20, v20 clamp
    v_exp_f32 v21, v21 clamp
    v_exp_f32 v24, v24 clamp
    v_exp_f32 v25, v25 clamp
    v_pk_fma_f32 v[22:23], v[20:21], s[96:97], v[30:31]
    v_pk_fma_f32 v[26:27], v[24:25], s[96:97], v[30:31]
    v_pk_mul_f32 v[20:21], v[20:21], v[22:23]
    v_pk_mul_f32 v[24:25], v[24:25], v[26:27]
    v_pk_add_f32 v[22:23], v[20:21], s[98:99]
    v_pk_add_f32 v[26:27], v[24:25], s[98:99]
    v_rcp_f32 v22, v22
    v_rcp_f32 v23, v23
    v_rcp_f32 v26, v26
    v_rcp_f32 v27, v27
    v_pk_mul_f32 v[20:21], v[168:169], v[20:21]
    v_pk_mul_f32 v[24:25], v[170:171], v[24:25]
    v_pk_mul_f32 v[20:21], v[20:21], v[22:23]
    v_pk_mul_f32 v[24:25], v[24:25], v[26:27]
    v_cvt_pk_bf16_f32 v240, v20, v21
    v_cvt_pk_bf16_f32 v241, v24, v25
    v_pk_fma_f32 v[20:21], v[200:201], v[230:231], v[216:217]
    v_pk_fma_f32 v[24:25], v[202:203], v[230:231], v[218:219]
    v_pk_fma_f32 v[172:173], v[172:173], v[194:195], v[20:21] op_sel_hi:[1,0,1]
    v_pk_fma_f32 v[174:175], v[174:175], v[194:195], v[24:25] op_sel_hi:[1,0,1]
    v_pk_add_f32 v[20:21], v[172:173], s[94:95]
    v_pk_add_f32 v[24:25], v[174:175], s[94:95]
    v_exp_f32 v20, v20 clamp
    v_exp_f32 v21, v21 clamp
    v_exp_f32 v24, v24 clamp
    v_exp_f32 v25, v25 clamp
    v_pk_fma_f32 v[22:23], v[20:21], s[96:97], v[30:31]
    v_pk_fma_f32 v[26:27], v[24:25], s[96:97], v[30:31]
    v_pk_mul_f32 v[20:21], v[20:21], v[22:23]
    v_pk_mul_f32 v[24:25], v[24:25], v[26:27]
    v_pk_add_f32 v[22:23], v[20:21], s[98:99]
    v_pk_add_f32 v[26:27], v[24:25], s[98:99]
    v_rcp_f32 v22, v22
    v_rcp_f32 v23, v23
    v_rcp_f32 v26, v26
    v_rcp_f32 v27, v27
    v_pk_mul_f32 v[20:21], v[172:173], v[20:21]
    v_pk_mul_f32 v[24:25], v[174:175], v[24:25]
    v_pk_mul_f32 v[20:21], v[20:21], v[22:23]
    v_pk_mul_f32 v[24:25], v[24:25], v[26:27]
    v_cvt_pk_bf16_f32 v242, v20, v21
    v_cvt_pk_bf16_f32 v243, v24, v25
    v_pk_fma_f32 v[20:21], v[204:205], v[230:231], v[220:221]
    v_pk_fma_f32 v[24:25], v[206:207], v[230:231], v[222:223]
    v_pk_fma_f32 v[176:177], v[176:177], v[194:195], v[20:21] op_sel_hi:[1,0,1]
    v_pk_fma_f32 v[178:179], v[178:179], v[194:195], v[24:25] op_sel_hi:[1,0,1]
    v_pk_add_f32 v[20:21], v[176:177], s[94:95]
    v_pk_add_f32 v[24:25], v[178:179], s[94:95]
    v_exp_f32 v20, v20 clamp
    v_exp_f32 v21, v21 clamp
    v_exp_f32 v24, v24 clamp
    v_exp_f32 v25, v25 clamp
    v_pk_fma_f32 v[22:23], v[20:21], s[96:97], v[30:31]
    v_pk_fma_f32 v[26:27], v[24:25], s[96:97], v[30:31]
    v_pk_mul_f32 v[20:21], v[20:21], v[22:23]
    v_pk_mul_f32 v[24:25], v[24:25], v[26:27]
    v_pk_add_f32 v[22:23], v[20:21], s[98:99]
    v_pk_add_f32 v[26:27], v[24:25], s[98:99]
    v_rcp_f32 v22, v22
    v_rcp_f32 v23, v23
    v_rcp_f32 v26, v26
    v_rcp_f32 v27, v27
    v_pk_mul_f32 v[20:21], v[176:177], v[20:21]
    v_pk_mul_f32 v[24:25], v[178:179], v[24:25]
    v_pk_mul_f32 v[20:21], v[20:21], v[22:23]
    v_pk_mul_f32 v[24:25], v[24:25], v[26:27]
    v_cvt_pk_bf16_f32 v244, v20, v21
    v_cvt_pk_bf16_f32 v245, v24, v25
    v_pk_fma_f32 v[20:21], v[208:209], v[230:231], v[224:225]
    v_pk_fma_f32 v[24:25], v[210:211], v[230:231], v[226:227]
    v_pk_fma_f32 v[180:181], v[180:181], v[194:195], v[20:21] op_sel_hi:[1,0,1]
    v_pk_fma_f32 v[182:183], v[182:183], v[194:195], v[24:25] op_sel_hi:[1,0,1]
    v_pk_add_f32 v[20:21], v[180:181], s[94:95]
    v_pk_add_f32 v[24:25], v[182:183], s[94:95]
    v_exp_f32 v20, v20 clamp
    v_exp_f32 v21, v21 clamp
    v_exp_f32 v24, v24 clamp
    v_exp_f32 v25, v25 clamp
    v_pk_fma_f32 v[22:23], v[20:21], s[96:97], v[30:31]
    v_pk_fma_f32 v[26:27], v[24:25], s[96:97], v[30:31]
    v_pk_mul_f32 v[20:21], v[20:21], v[22:23]
    v_pk_mul_f32 v[24:25], v[24:25], v[26:27]
    v_pk_add_f32 v[22:23], v[20:21], s[98:99]
    v_pk_add_f32 v[26:27], v[24:25], s[98:99]
    v_rcp_f32 v22, v22
    v_rcp_f32 v23, v23
    v_rcp_f32 v26, v26
    v_rcp_f32 v27, v27
    v_pk_mul_f32 v[20:21], v[180:181], v[20:21]
    v_pk_mul_f32 v[24:25], v[182:183], v[24:25]
    v_pk_mul_f32 v[20:21], v[20:21], v[22:23]
    v_pk_mul_f32 v[24:25], v[24:25], v[26:27]
    v_cvt_pk_bf16_f32 v246, v20, v21
    v_cvt_pk_bf16_f32 v247, v24, v25
    s_waitcnt vmcnt(2)
    s_barrier
    s_cmp_lg_u32 s70, 0
    s_cbranch_scc1 EB_8
    v_mov_b32 v4, s3
    s_mov_b64 exec, 1
    buffer_store_dword v4, off, s[44:47], s67 sc1
    s_mov_b64 exec, -1
EB_8:
    s_add_u32 s87, s42, 143360
    buffer_store_dwordx4 v[240:243], v34, s[44:47], s87 offen offset:0 sc1
    buffer_store_dwordx4 v[244:247], v34, s[44:47], s87 offen offset:1024 sc1
EN_6:
    s_waitcnt vmcnt(4)
    s_branch L_pub
L_eq:
    s_cmp_eq_u32 s64, 2
    s_cbranch_scc1 L_t2
    s_cmp_eq_u32 s80, 2
    s_cbranch_scc1 EZ_7
    s_mov_b32 s94, 0x3fb8aa3b
    s_mov_b32 s95, 0x3fb8aa3b
    s_mov_b32 s96, s93
    s_mov_b32 s97, s93
    s_nop 0
    v_pk_fma_f32 v[20:21], v[196:197], v[186:187], s[96:97]
    v_pk_fma_f32 v[24:25], v[198:199], v[186:187], s[96:97]
    v_pk_fma_f32 v[152:153], v[152:153], v[184:185], v[20:21] op_sel_hi:[1,0,1]
    v_pk_fma_f32 v[154:155], v[154:155], v[184:185], v[24:25] op_sel_hi:[1,0,1]
    v_pk_mul_f32 v[20:21], v[152:153], s[94:95]
    v_pk_mul_f32 v[24:25], v[154:155], s[94:95]
    v_exp_f32 v20, v20 clamp
    v_exp_f32 v21, v21 clamp
    v_exp_f32 v24, v24 clamp
    v_exp_f32 v25, v25 clamp
    v_max_f32 v152, s93, v152
    v_max_f32 v153, s93, v153
    v_max_f32 v154, s93, v154
    v_max_f32 v155, s93, v155
    v_pk_add_f32 v[152:153], v[152:153], v[20:21]
    v_pk_add_f32 v[154:155], v[154:155], v[24:25]
    v_cvt_pk_bf16_f32 v232, v152, v153
    v_cvt_pk_bf16_f32 v233, v154, v155
    v_pk_fma_f32 v[20:21], v[200:201], v[186:187], s[96:97]
    v_pk_fma_f32 v[24:25], v[202:203], v[186:187], s[96:97]
    v_pk_fma_f32 v[156:157], v[156:157], v[184:185], v[20:21] op_sel_hi:[1,0,1]
    v_pk_fma_f32 v[158:159], v[158:159], v[184:185], v[24:25] op_sel_hi:[1,0,1]
    v_pk_mul_f32 v[20:21], v[156:157], s[94:95]
    v_pk_mul_f32 v[24:25], v[158:159], s[94:95]
    v_exp_f32 v20, v20 clamp
    v_exp_f32 v21, v21 clamp
    v_exp_f32 v24, v24 clamp
    v_exp_f32 v25, v25 clamp
    v_max_f32 v156, s93, v156
    v_max_f32 v157, s93, v157
    v_max_f32 v158, s93, v158
    v_max_f32 v159, s93, v159
    v_pk_add_f32 v[156:157], v[156:157], v[20:21]
    v_pk_add_f32 v[158:159], v[158:159], v[24:25]
    v_cvt_pk_bf16_f32 v234, v156, v157
    v_cvt_pk_bf16_f32 v235, v158, v159
    v_pk_fma_f32 v[20:21], v[204:205], v[186:187], s[96:97]
    v_pk_fma_f32 v[24:25], v[206:207], v[186:187], s[96:97]
    v_pk_fma_f32 v[160:161], v[160:161], v[184:185], v[20:21] op_sel_hi:[1,0,1]
    v_pk_fma_f32 v[162:163], v[162:163], v[184:185], v[24:25] op_sel_hi:[1,0,1]
    v_pk_mul_f32 v[20:21], v[160:161], s[94:95]
    v_pk_mul_f32 v[24:25], v[162:163], s[94:95]
    v_exp_f32 v20, v20 clamp
    v_exp_f32 v21, v21 clamp
    v_exp_f32 v24, v24 clamp
    v_exp_f32 v25, v25 clamp
    v_max_f32 v160, s93, v160
    v_max_f32 v161, s93, v161
    v_max_f32 v162, s93, v162
    v_max_f32 v163, s93, v163
    v_pk_add_f32 v[160:161], v[160:161], v[20:21]
    v_pk_add_f32 v[162:163], v[162:163], v[24:25]
    v_cvt_pk_bf16_f32 v236, v160, v161
    v_cvt_pk_bf16_f32 v237, v162, v163
    v_pk_fma_f32 v[20:21], v[208:209], v[186:187], s[96:97]
    v_pk_fma_f32 v[24:25], v[210:211], v[186:187], s[96:97]
    v_pk_fma_f32 v[164:165], v[164:165], v[184:185], v[20:21] op_sel_hi:[1,0,1]
    v_pk_fma_f32 v[166:167], v[166:167], v[184:185], v[24:25] op_sel_hi:[1,0,1]
    v_pk_mul_f32 v[20:21], v[164:165], s[94:95]
    v_pk_mul_f32 v[24:25], v[166:167], s[94:95]
    v_exp_f32 v20, v20 clamp
    v_exp_f32 v21, v21 clamp
    v_exp_f32 v24, v24 clamp
    v_exp_f32 v25, v25 clamp
    v_max_f32 v164, s93, v164
    v_max_f32 v165, s93, v165
    v_max_f32 v166, s93, v166
    v_max_f32 v167, s93, v167
    v_pk_add_f32 v[164:165], v[164:165], v[20:21]
    v_pk_add_f32 v[166:167], v[166:167], v[24:25]
    v_cvt_pk_bf16_f32 v238, v164, v165
    v_cvt_pk_bf16_f32 v239, v166, v167
    s_add_u32 s87, s42, 0
    s_nop 0
    buffer_store_dwordx4 v[232:235], v34, s[44:47], s87 offen offset:0 sc1
    buffer_store_dwordx4 v[236:239], v34, s[44:47], s87 offen offset:1024 sc1
    v_pk_fma_f32 v[20:21], v[196:197], v[190:191], s[96:97]
    v_pk_fma_f32 v[24:25], v[198:199], v[190:191], s[96:97]
    v_pk_fma_f32 v[168:169], v[168:169], v[188:189], v[20:21] op_sel_hi:[1,0,1]
    v_pk_fma_f32 v[170:171], v[170:171], v[188:189], v[24:25] op_sel_hi:[1,0,1]
    v_pk_mul_f32 v[20:21], v[168:169], s[94:95]
    v_pk_mul_f32 v[24:25], v[170:171], s[94:95]
    v_exp_f32 v20, v20 clamp
    v_exp_f32 v21, v21 clamp
    v_exp_f32 v24, v24 clamp
    v_exp_f32 v25, v25 clamp
    v_max_f32 v168, s93, v168
    v_max_f32 v169, s93, v169
    v_max_f32 v170, s93, v170
    v_max_f32 v171, s93, v171
    v_pk_add_f32 v[168:169], v[168:169], v[20:21]
    v_pk_add_f32 v[170:171], v[170:171], v[24:25]
    v_cvt_pk_bf16_f32 v240, v168, v169
    v_cvt_pk_bf16_f32 v241, v170, v171
    v_pk_fma_f32 v[20:21], v[200:201], v[190:191], s[96:97]
    v_pk_fma_f32 v[24:25], v[202:203], v[190:191], s[96:97]
    v_pk_fma_f32 v[172:173], v[172:173], v[188:189], v[20:21] op_sel_hi:[1,0,1]
    v_pk_fma_f32 v[174:175], v[174:175], v[188:189], v[24:25] op_sel_hi:[1,0,1]
    v_pk_mul_f32 v[20:21], v[172:173], s[94:95]
    v_pk_mul_f32 v[24:25], v[174:175], s[94:95]
    v_exp_f32 v20, v20 clamp
    v_exp_f32 v21, v21 clamp
    v_exp_f32 v24, v24 clamp
    v_exp_f32 v25, v25 clamp
    v_max_f32 v172, s93, v172
    v_max_f32 v173, s93, v173
    v_max_f32 v174, s93, v174
    v_max_f32 v175, s93, v175
    v_pk_add_f32 v[172:173], v[172:173], v[20:21]
    v_pk_add_f32 v[174:175], v[174:175], v[24:25]
    v_cvt_pk_bf16_f32 v242, v172, v173
    v_cvt_pk_bf16_f32 v243, v174, v175
    v_pk_fma_f32 v[20:21], v[204:205], v[190:191], s[96:97]
    v_pk_fma_f32 v[24:25], v[206:207], v[190:191], s[96:97]
    v_pk_fma_f32 v[176:177], v[176:177], v[188:189], v[20:21] op_sel_hi:[1,0,1]
    v_pk_fma_f32 v[178:179], v[178:179], v[188:189], v[24:25] op_sel_hi:[1,0,1]
    v_pk_mul_f32 v[20:21], v[176:177], s[94:95]
    v_pk_mul_f32 v[24:25], v[178:179], s[94:95]
    v_exp_f32 v20, v20 clamp
    v_exp_f32 v21, v21 clamp
    v_exp_f32 v24, v24 clamp
    v_exp_f32 v25, v25 clamp
    v_max_f32 v176, s93, v176
    v_max_f32 v177, s93, v177
    v_max_f32 v178, s93, v178
    v_max_f32 v179, s93, v179
    v_pk_add_f32 v[176:177], v[176:177], v[20:21]
    v_pk_add_f32 v[178:179], v[178:179], v[24:25]
    v_cvt_pk_bf16_f32 v244, v176, v177
    v_cvt_pk_bf16_f32 v245, v178, v179
    v_pk_fma_f32 v[20:21], v[208:209], v[190:191], s[96:97]
    v_pk_fma_f32 v[24:25], v[210:211], v[190:191], s[96:97]
    v_pk_fma_f32 v[180:181], v[180:181], v[188:189], v[20:21] op_sel_hi:[1,0,1]
    v_pk_fma_f32 v[182:183], v[182:183], v[188:189], v[24:25] op_sel_hi:[1,0,1]
    v_pk_mul_f32 v[20:21], v[180:181], s[94:95]
    v_pk_mul_f32 v[24:25], v[182:183], s[94:95]
    v_exp_f32 v20, v20 clamp
    v_exp_f32 v21, v21 clamp
    v_exp_f32 v24, v24 clamp
    v_exp_f32 v25, v25 clamp
    v_max_f32 v180, s93, v180
    v_max_f32 v181, s93, v181
    v_max_f32 v182, s93, v182
    v_max_f32 v183, s93, v183
    v_pk_add_f32 v[180:181], v[180:181], v[20:21]
    v_pk_add_f32 v[182:183], v[182:183], v[24:25]
    v_cvt_pk_bf16_f32 v246, v180, v181
    v_cvt_pk_bf16_f32 v247, v182, v183
    s_waitcnt vmcnt(2)
    s_barrier
    s_cmp_lg_u32 s70, 0
    s_cbranch_scc1 EB_9
    v_mov_b32 v4, s3
    s_mov_b64 exec, 1
    buffer_store_dword v4, off, s[44:47], s67 sc1
    s_mov_b64 exec, -1
EB_9:
    s_add_u32 s87, s42, 143360
    buffer_store_dwordx4 v[240:243], v34, s[44:47], s87 offen offset:0 sc1
    buffer_store_dwordx4 v[244:247], v34, s[44:47], s87 offen offset:1024 sc1
    s_branch EN_6
EZ_7:
    s_waitcnt vmcnt(0)
    s_barrier
    s_cmp_lg_u32 s70, 0
    s_cbranch_scc1 EB_10
    v_mov_b32 v4, s3
    s_mov_b64 exec, 1
    buffer_store_dword v4, off, s[44:47], s67 sc1
    s_mov_b64 exec, -1
EB_10:
    s_branch EN_6
L_kv:
    v_xor_b32 v249, 32, v248
    v_xor_b32 v250, 64, v248
    v_xor_b32 v251, 96, v248
    v_lshl_add_u32 v6, v37, 6, v38
    s_mul_i32 s87, s70, 56
    v_add_u32 v6, s87, v6
    v_add_u32 v7, 0, v6
    v_and_b32 v7, 511, v7
    v_lshl_add_u32 v7, v36, 9, v7
    v_add_u32 v32, 49152, v7
    v_add_u32 v33, 114688, v7
    v_add_u32 v7, 224, v6
    v_and_b32 v7, 511, v7
    v_lshl_add_u32 v7, v36, 9, v7
    v_add_u32 v34, 49152, v7
    v_add_u32 v35, 114688, v7
    s_waitcnt vmcnt(8)
    s_mov_b32 s87, 0x3f803f80
    v_mov_b32 v4, 0
    v_mov_b32 v5, 0
    v_dot2c_f32_bf16 v4, s87, v8
    v_dot2c_f32_bf16 v5, v8, v8
    v_dot2c_f32_bf16 v4, s87, v9
    v_dot2c_f32_bf16 v5, v9, v9
    v_dot2c_f32_bf16 v4, s87, v10
    v_dot2c_f32_bf16 v5, v10, v10
    v_dot2c_f32_bf16 v4, s87, v11
    v_dot2c_f32_bf16 v5, v11, v11
    v_dot2c_f32_bf16 v4, s87, v12
    v_dot2c_f32_bf16 v5, v12, v12
    v_dot2c_f32_bf16 v4, s87, v13
    v_dot2c_f32_bf16 v5, v13, v13
    v_dot2c_f32_bf16 v4, s87, v14
    v_dot2c_f32_bf16 v5, v14, v14
    v_dot2c_f32_bf16 v4, s87, v15
    v_dot2c_f32_bf16 v5, v15, v15
    s_nop 1
    v_add_f32_dpp v4, v4, v4 row_shr:1 row_mask:0xf bank_mask:0xf bound_ctrl:1
    v_add_f32_dpp v5, v5, v5 row_shr:1 row_mask:0xf bank_mask:0xf bound_ctrl:1
    s_nop 0
    v_add_f32_dpp v4, v4, v4 row_shr:2 row_mask:0xf bank_mask:0xf bound_ctrl:1
    v_add_f32_dpp v5, v5, v5 row_shr:2 row_mask:0xf bank_mask:0xf bound_ctrl:1
    s_nop 0
    v_add_f32_dpp v4, v4, v4 row_shr:4 row_mask:0xf bank_mask:0xf bound_ctrl:1
    v_add_f32_dpp v5, v5, v5 row_shr:4 row_mask:0xf bank_mask:0xf bound_ctrl:1
    s_nop 0
    v_add_f32_dpp v4, v4, v4 row_shr:8 row_mask:0xf bank_mask:0xf bound_ctrl:1
    v_add_f32_dpp v5, v5, v5 row_shr:8 row_mask:0xf bank_mask:0xf bound_ctrl:1
    s_nop 0
    v_add_f32_dpp v4, v4, v4 row_bcast:15 row_mask:0xa bank_mask:0xf
    v_add_f32_dpp v5, v5, v5 row_bcast:15 row_mask:0xa bank_mask:0xf
    v_mul_f32 v4, 0x3b124925, v4
    v_mul_f32 v5, 0x3b124925, v5
    v_fma_f32 v5, -v4, v4, v5
    v_max_f32 v5, 0, v5
    v_cvt_pk_bf16_f32 v6, v4, v5
    v_lshlrev_b32 v4, 16, v6
    v_and_b32 v5, 0xffff0000, v6
    v_add_f32 v5, 0x3727c5ac, v5
    v_cvt_pk_bf16_f32 v5, v5, v5
    v_lshlrev_b32 v5, 16, v5
    v_sqrt_f32 v5, v5
    s_nop 0
    v_cvt_pk_bf16_f32 v5, v5, v5
    v_lshlrev_b32 v5, 16, v5
    v_rcp_f32 v8, v5
    s_nop 0
    v_mul_f32 v10, v4, v8
    v_sub_f32 v10, 0, v10
    s_lshl_b32 s73, s72, 7
    s_add_u32 s73, s73, s43
    s_mul_i32 s74, s72, 172032
    s_add_u32 s75, s74, 21504
    s_add_u32 s72, s72, 1
    s_cmp_eq_u32 s72, 7
    s_cselect_b32 s72, 0, s72
    s_add_u32 m0, s6, 16384
    s_nop 0
    buffer_load_dwordx4 v16, s[28:31], s73 offen offset:0 lds
    buffer_load_dwordx4 v17, s[28:31], s73 offen offset:1024 lds
    buffer_load_dwordx4 v252, s[28:31], s73 offen offset:2048 lds
    buffer_load_dwordx4 v253, s[28:31], s73 offen offset:3072 lds
    s_add_u32 m0, s7, 81920
    s_nop 0
    buffer_load_dwordx4 v20, s[32:35], s74 offen offset:0 lds
    buffer_load_dwordx4 v21, s[32:35], s74 offen offset:1024 lds
    buffer_load_dwordx4 v22, s[32:35], s74 offen offset:2048 lds
    buffer_load_dwordx4 v23, s[32:35], s74 offen offset:3072 lds
    s_add_u32 m0, s7, 86016
    s_nop 0
    buffer_load_dwordx4 v20, s[32:35], s75 offen offset:0 lds
    buffer_load_dwordx4 v21, s[32:35], s75 offen offset:1024 lds
    buffer_load_dwordx4 v22, s[32:35], s75 offen offset:2048 lds
    buffer_load_dwordx4 v23, s[32:35], s75 offen offset:3072 lds
    buffer_load_dword v27, off, s[48:51], 0 sc1
    s_waitcnt vmcnt(13)
    s_barrier
    ds_read_b128 v[44:47], v248 offset:0
    ds_read_b64_tr_b16 v[60:61], v32 offset:0
    ds_read_b64_tr_b16 v[62:63], v32 offset:2048
    ds_read_b64_tr_b16 v[64:65], v34 offset:0
    ds_read_b64_tr_b16 v[66:67], v34 offset:2048
    ds_read_b128 v[48:51], v248 offset:4096
    ds_read_b128 v[52:55], v248 offset:8192
    ds_read_b128 v[56:59], v248 offset:12288
    s_lshl_b32 s73, s72, 7
    s_add_u32 s73, s73, s43
    s_mul_i32 s74, s72, 172032
    s_add_u32 s75, s74, 21504
    s_add_u32 s72, s72, 1
    s_cmp_eq_u32 s72, 7
    s_cselect_b32 s72, 0, s72
    s_waitcnt lgkmcnt(3)
    v_mfma_f32_32x32x16_bf16 v[92:107], v[44:47], v[60:63], 0
    ds_read_b128 v[68:71], v249 offset:0
    ds_read_b64_tr_b16 v[84:85], v32 offset:8192
    s_cmp_lt_u32 s68, 14
    s_cselect_b32 s87, 0, 1073741824
    s_add_u32 m0, s6, 32768
    v_mfma_f32_32x32x16_bf16 v[108:123], v[44:47], v[64:67], 0
    buffer_load_dwordx4 v16, s[28:31], s73 offen offset:0 lds
    ds_read_b64_tr_b16 v[86:87], v32 offset:10240
    ds_read_b64_tr_b16 v[88:89], v34 offset:8192
    s_waitcnt lgkmcnt(4)
    v_mfma_f32_32x32x16_bf16 v[124:139], v[48:51], v[60:63], 0
    ds_read_b64_tr_b16 v[90:91], v34 offset:10240
    ds_read_b128 v[72:75], v249 offset:4096
    v_mfma_f32_32x32x16_bf16 v[140:155], v[48:51], v[64:67], 0
    buffer_load_dwordx4 v17, s[28:31], s73 offen offset:1024 lds
    ds_read_b128 v[76:79], v249 offset:8192
    ds_read_b128 v[80:83], v249 offset:12288
    v_mfma_f32_32x32x16_bf16 v[156:171], v[52:55], v[60:63], 0
    s_lshl_b32 s88, s70, 10
    v_mfma_f32_32x32x16_bf16 v[172:187], v[52:55], v[64:67], 0
    buffer_load_dwordx4 v252, s[28:31], s73 offen offset:2048 lds
    v_mfma_f32_32x32x16_bf16 v[188:203], v[56:59], v[60:63], 0
    v_mfma_f32_32x32x16_bf16 v[204:219], v[56:59], v[64:67], 0
    buffer_load_dwordx4 v253, s[28:31], s73 offen offset:3072 lds
    v_mfma_f32_16x16x32_bf16 v[36:39], v[28:31], v[60:63], 0
    v_mfma_f32_16x16x32_bf16 v[40:43], v[28:31], v[64:67], 0
    s_waitcnt lgkmcnt(3)
    v_mfma_f32_32x32x16_bf16 v[92:107], v[68:71], v[84:87], v[92:107]
    ds_read_b128 v[44:47], v250 offset:0
    ds_read_b64_tr_b16 v[60:61], v32 offset:16384
    v_lshl_add_u32 v26, v1, 4, s88
    s_add_u32 m0, s7, 114688
    v_mfma_f32_32x32x16_bf16 v[108:123], v[68:71], v[88:91], v[108:123]
    buffer_load_dwordx4 v20, s[32:35], s74 offen offset:0 lds
    ds_read_b64_tr_b16 v[62:63], v32 offset:18432
    ds_read_b64_tr_b16 v[64:65], v34 offset:16384
    s_waitcnt lgkmcnt(4)
    v_mfma_f32_32x32x16_bf16 v[124:139], v[72:75], v[84:87], v[124:139]
    ds_read_b64_tr_b16 v[66:67], v34 offset:18432
    ds_read_b128 v[48:51], v250 offset:4096
    v_mfma_f32_32x32x16_bf16 v[140:155], v[72:75], v[88:91], v[140:155]
    buffer_load_dwordx4 v21, s[32:35], s74 offen offset:1024 lds
    ds_read_b128 v[52:55], v250 offset:8192
    ds_read_b128 v[56:59], v250 offset:12288
    v_mfma_f32_32x32x16_bf16 v[156:171], v[76:79], v[84:87], v[156:171]
    v_add_u32 v12, s87, v26
    v_mfma_f32_32x32x16_bf16 v[172:187], v[76:79], v[88:91], v[172:187]
    buffer_load_dwordx4 v22, s[32:35], s74 offen offset:2048 lds
    v_mfma_f32_32x32x16_bf16 v[188:203], v[80:83], v[84:87], v[188:203]
    v_mfma_f32_32x32x16_bf16 v[204:219], v[80:83], v[88:91], v[204:219]
    buffer_load_dwordx4 v23, s[32:35], s74 offen offset:3072 lds
    v_mfma_f32_16x16x32_bf16 v[36:39], v[28:31], v[84:87], v[36:39]
    v_mfma_f32_16x16x32_bf16 v[40:43], v[28:31], v[88:91], v[40:43]
    s_waitcnt lgkmcnt(3)
    v_mfma_f32_32x32x16_bf16 v[92:107], v[44:47], v[60:63], v[92:107]
    ds_read_b128 v[68:71], v251 offset:0
    ds_read_b64_tr_b16 v[84:85], v32 offset:24576
    s_nop 1
    s_add_u32 m0, s7, 118784
    v_mfma_f32_32x32x16_bf16 v[108:123], v[44:47], v[64:67], v[108:123]
    buffer_load_dwordx4 v20, s[32:35], s75 offen offset:0 lds
    ds_read_b64_tr_b16 v[86:87], v32 offset:26624
    ds_read_b64_tr_b16 v[88:89], v34 offset:24576
    s_waitcnt lgkmcnt(4)
    s_nop 0
    v_mfma_f32_32x32x16_bf16 v[124:139], v[48:51], v[60:63], v[124:139]
    ds_read_b64_tr_b16 v[90:91], v34 offset:26624
    ds_read_b128 v[72:75], v251 offset:4096
    v_cndmask_b32 v36, v37, v36, s[98:99]
    v_mfma_f32_32x32x16_bf16 v[140:155], v[48:51], v[64:67], v[140:155]
    buffer_load_dwordx4 v21, s[32:35], s75 offen offset:1024 lds
    ds_read_b128 v[76:79], v251 offset:8192
    ds_read_b128 v[80:83], v251 offset:12288
    v_mfma_f32_32x32x16_bf16 v[156:171], v[52:55], v[60:63], v[156:171]
    v_cndmask_b32 v40, v41, v40, s[98:99]
    v_mfma_f32_32x32x16_bf16 v[172:187], v[52:55], v[64:67], v[172:187]
    buffer_load_dwordx4 v22, s[32:35], s75 offen offset:2048 lds
    v_mfma_f32_32x32x16_bf16 v[188:203], v[56:59], v[60:63], v[188:203]
    v_cndmask_b32 v4, v40, v36, s[96:97]
    v_mfma_f32_32x32x16_bf16 v[204:219], v[56:59], v[64:67], v[204:219]
    buffer_load_dwordx4 v23, s[32:35], s75 offen offset:3072 lds
    s_waitcnt vmcnt(13) lgkmcnt(0)
    s_barrier
    v_mfma_f32_32x32x16_bf16 v[92:107], v[68:71], v[84:87], v[92:107]
    ds_read_b128 v[44:47], v248 offset:16384
    ds_read_b64_tr_b16 v[60:61], v32 offset:32768
    s_lshl_b32 s73, s72, 7
    s_add_u32 s73, s73, s43
    s_mul_i32 s74, s72, 172032
    s_add_u32 s75, s74, 21504
    s_add_u32 s72, s72, 1
    s_cmp_eq_u32 s72, 7
    s_cselect_b32 s72, 0, s72
    s_waitcnt vmcnt(12)
    s_add_u32 m0, s6, 0
    v_mfma_f32_32x32x16_bf16 v[108:123], v[68:71], v[88:91], v[108:123]
    buffer_load_dwordx4 v16, s[28:31], s73 offen offset:0 lds
    ds_read_b64_tr_b16 v[62:63], v32 offset:34816
    ds_read_b64_tr_b16 v[64:65], v34 offset:32768
    s_mov_b32 s92, 30000
NT_11:
    v_readfirstlane_b32 s3, v27
    s_nop 0
    s_sub_u32 s89, s3, s66
    s_add_u32 s89, s89, 4096
    s_lshr_b32 s89, s89, 13
    s_andn2_b32 s67, 1, s3
    s_or_b32 s89, s89, s67
    s_cbranch_scc0 ND_12
    s_sub_u32 s92, s92, 1
    s_cmp_eq_u32 s92, 0
    s_cbranch_scc1 ND_12
    buffer_load_dword v27, off, s[48:51], 0 sc1
    s_waitcnt vmcnt(0)
    s_branch NT_11
ND_12:
    v_mfma_f32_32x32x16_bf16 v[124:139], v[72:75], v[84:87], v[124:139]
    ds_read_b64_tr_b16 v[66:67], v34 offset:34816
    ds_read_b128 v[48:51], v248 offset:20480
    v_mov_b32 v9, s3
    v_mfma_f32_32x32x16_bf16 v[140:155], v[72:75], v[88:91], v[140:155]
    buffer_load_dwordx4 v17, s[28:31], s73 offen offset:1024 lds
    ds_read_b128 v[52:55], v248 offset:24576
    ds_read_b128 v[56:59], v248 offset:28672
    v_mov_b32 v11, s3
    v_mfma_f32_32x32x16_bf16 v[156:171], v[76:79], v[84:87], v[156:171]
    v_mov_b32 v5, s3
    v_mfma_f32_32x32x16_bf16 v[172:187], v[76:79], v[88:91], v[172:187]
    buffer_load_dwordx4 v252, s[28:31], s73 offen offset:2048 lds
    buffer_store_dwordx4 v[8:11], v18, s[44:47], s65 offen sc1
    v_mfma_f32_32x32x16_bf16 v[188:203], v[80:83], v[84:87], v[188:203]
    buffer_store_dwordx2 v[4:5], v12, s[44:47], s85 offen sc1
    v_mfma_f32_32x32x16_bf16 v[204:219], v[80:83], v[88:91], v[204:219]
    buffer_load_dwordx4 v253, s[28:31], s73 offen offset:3072 lds
    s_waitcnt lgkmcnt(3)
    v_mfma_f32_32x32x16_bf16 v[92:107], v[44:47], v[60:63], v[92:107]
    ds_read_b128 v[68:71], v249 offset:16384
    ds_read_b64_tr_b16 v[84:85], v32 offset:40960
    s_add_u32 m0, s7, 49152
    v_mfma_f32_32x32x16_bf16 v[108:123], v[44:47], v[64:67], v[108:123]
    buffer_load_dwordx4 v20, s[32:35], s74 offen offset:0 lds
    ds_read_b64_tr_b16 v[86:87], v32 offset:43008
    ds_read_b64_tr_b16 v[88:89], v34 offset:40960
    s_waitcnt lgkmcnt(4)
    v_mfma_f32_32x32x16_bf16 v[124:139], v[48:51], v[60:63], v[124:139]
    ds_read_b64_tr_b16 v[90:91], v34 offset:43008
    ds_read_b128 v[72:75], v249 offset:20480
    v_mfma_f32_32x32x16_bf16 v[140:155], v[48:51], v[64:67], v[140:155]
    buffer_load_dwordx4 v21, s[32:35], s74 offen offset:1024 lds
    ds_read_b128 v[76:79], v249 offset:24576
    ds_read_b128 v[80:83], v249 offset:28672
    v_mfma_f32_32x32x16_bf16 v[156:171], v[52:55], v[60:63], v[156:171]
    v_mfma_f32_32x32x16_bf16 v[172:187], v[52:55], v[64:67], v[172:187]
    buffer_load_dwordx4 v22, s[32:35], s74 offen offset:2048 lds
    v_mfma_f32_32x32x16_bf16 v[188:203], v[56:59], v[60:63], v[188:203]
    v_mfma_f32_32x32x16_bf16 v[204:219], v[56:59], v[64:67], v[204:219]
    buffer_load_dwordx4 v23, s[32:35], s74 offen offset:3072 lds
    s_waitcnt lgkmcnt(3)
    v_mfma_f32_32x32x16_bf16 v[92:107], v[68:71], v[84:87], v[92:107]
    ds_read_b128 v[44:47], v250 offset:16384
    ds_read_b64_tr_b16 v[60:61], v32 offset:49152
    v_and_b32 v4, 31, v1
    s_add_u32 m0, s7, 53248
    v_mfma_f32_32x32x16_bf16 v[108:123], v[68:71], v[88:91], v[108:123]
    buffer_load_dwordx4 v20, s[32:35], s75 offen offset:0 lds
    ds_read_b64_tr_b16 v[62:63], v32 offset:51200
    ds_read_b64_tr_b16 v[64:65], v34 offset:49152
    v_lshlrev_b32 v18, 4, v4
    s_waitcnt lgkmcnt(4)
    v_mfma_f32_32x32x16_bf16 v[124:139], v[72:75], v[84:87], v[124:139]
    ds_read_b64_tr_b16 v[66:67], v34 offset:51200
    ds_read_b128 v[48:51], v250 offset:20480
    s_lshl_b32 s87, s68, 2
    v_mfma_f32_32x32x16_bf16 v[140:155], v[72:75], v[88:91], v[140:155]
    buffer_load_dwordx4 v21, s[32:35], s75 offen offset:1024 lds
    ds_read_b128 v[52:55], v250 offset:24576
    ds_read_b128 v[56:59], v250 offset:28672
    s_add_u32 s87, s87, s70
    v_mfma_f32_32x32x16_bf16 v[156:171], v[76:79], v[84:87], v[156:171]
    s_lshl_b32 s87, s87, 9
    v_mfma_f32_32x32x16_bf16 v[172:187], v[76:79], v[88:91], v[172:187]
    buffer_load_dwordx4 v22, s[32:35], s75 offen offset:2048 lds
    s_add_u32 s40, s87, 9502720
    v_mfma_f32_32x32x16_bf16 v[188:203], v[80:83], v[84:87], v[188:203]
    s_lshl_b32 s87, s70, 7
    v_mfma_f32_32x32x16_bf16 v[204:219], v[80:83], v[88:91], v[204:219]
    buffer_load_dwordx4 v23, s[32:35], s75 offen offset:3072 lds
    s_waitcnt lgkmcnt(3)
    v_mfma_f32_32x32x16_bf16 v[92:107], v[44:47], v[60:63], v[92:107]
    ds_read_b128 v[68:71], v251 offset:16384
    ds_read_b64_tr_b16 v[84:85], v32 offset:57344
    s_add_u32 s87, s87, 161792
    v_mfma_f32_32x32x16_bf16 v[108:123], v[44:47], v[64:67], v[108:123]
    ds_read_b64_tr_b16 v[86:87], v32 offset:59392
    ds_read_b64_tr_b16 v[88:89], v34 offset:57344
    v_lshl_add_u32 v42, v4, 2, s87
    s_waitcnt lgkmcnt(4)
    v_mfma_f32_32x32x16_bf16 v[124:139], v[48:51], v[60:63], v[124:139]
    ds_read_b64_tr_b16 v[90:91], v34 offset:59392
    ds_read_b128 v[72:75], v251 offset:20480
    v_mov_b32 v36, 0x3f803f80
    v_mfma_f32_32x32x16_bf16 v[140:155], v[48:51], v[64:67], v[140:155]
    ds_read_b128 v[76:79], v251 offset:24576
    ds_read_b128 v[80:83], v251 offset:28672
    v_cmp_gt_u32 vcc, 30, v4
    v_mfma_f32_32x32x16_bf16 v[156:171], v[52:55], v[60:63], v[156:171]
    v_cmp_lt_u32 s[96:97], 27, v4
    v_mfma_f32_32x32x16_bf16 v[172:187], v[52:55], v[64:67], v[172:187]
    v_lshrrev_b32 v5, 5, v1
    v_mfma_f32_32x32x16_bf16 v[188:203], v[56:59], v[60:63], v[188:203]
    v_cndmask_b32 v36, 0, v36, vcc
    v_mfma_f32_32x32x16_bf16 v[204:219], v[56:59], v[64:67], v[204:219]
    s_waitcnt vmcnt(14) lgkmcnt(0)
    s_barrier
    v_mfma_f32_32x32x16_bf16 v[92:107], v[68:71], v[84:87], v[92:107]
    ds_read_b128 v[44:47], v248 offset:32768
    ds_read_b64_tr_b16 v[60:61], v33 offset:0
    s_lshl_b32 s73, s72, 7
    s_add_u32 s73, s73, s43
    s_mul_i32 s74, s72, 172032
    s_add_u32 s75, s74, 21504
    s_add_u32 s72, s72, 1
    s_cmp_eq_u32 s72, 7
    s_cselect_b32 s72, 0, s72
    v_lshlrev_b32 v5, 4, v5
    s_add_u32 m0, s6, 16384
    v_mfma_f32_32x32x16_bf16 v[108:123], v[68:71], v[88:91], v[108:123]
    buffer_load_dwordx4 v16, s[28:31], s73 offen offset:0 lds
    ds_read_b64_tr_b16 v[62:63], v33 offset:2048
    ds_read_b64_tr_b16 v[64:65], v35 offset:0
    v_add_u32 v37, 161792, v5
    v_mfma_f32_32x32x16_bf16 v[124:139], v[72:75], v[84:87], v[124:139]
    ds_read_b64_tr_b16 v[66:67], v35 offset:2048
    ds_read_b128 v[48:51], v248 offset:36864
    v_mov_b32 v5, v4
    v_mfma_f32_32x32x16_bf16 v[140:155], v[72:75], v[88:91], v[140:155]
    buffer_load_dwordx4 v17, s[28:31], s73 offen offset:1024 lds
    ds_read_b128 v[52:55], v248 offset:40960
    ds_read_b128 v[56:59], v248 offset:45056
    v_cmp_eq_u32 vcc, 26, v4
    s_nop 1
    v_cndmask_b32 v5, v5, 28, vcc
    v_mfma_f32_32x32x16_bf16 v[156:171], v[76:79], v[84:87], v[156:171]
    v_cmp_eq_u32 vcc, 27, v4
    s_nop 1
    v_cndmask_b32 v5, v5, 29, vcc
    v_mfma_f32_32x32x16_bf16 v[172:187], v[76:79], v[88:91], v[172:187]
    buffer_load_dwordx4 v252, s[28:31], s73 offen offset:2048 lds
    v_cmp_eq_u32 vcc, 28, v4
    s_nop 1
    v_cndmask_b32 v5, v5, 27, vcc
    v_mfma_f32_32x32x16_bf16 v[188:203], v[80:83], v[84:87], v[188:203]
    v_cmp_eq_u32 vcc, 29, v4
    s_nop 1
    v_cndmask_b32 v5, v5, 31, vcc
    v_mfma_f32_32x32x16_bf16 v[204:219], v[80:83], v[88:91], v[204:219]
    buffer_load_dwordx4 v253, s[28:31], s73 offen offset:3072 lds
    s_waitcnt lgkmcnt(3)
    v_mfma_f32_32x32x16_bf16 v[92:107], v[44:47], v[60:63], v[92:107]
    ds_read_b128 v[68:71], v249 offset:32768
    ds_read_b64_tr_b16 v[84:85], v33 offset:8192
    v_cmp_eq_u32 vcc, 30, v4
    s_nop 1
    v_cndmask_b32 v5, v5, 26, vcc
    s_add_u32 m0, s7, 81920
    v_mfma_f32_32x32x16_bf16 v[108:123], v[44:47], v[64:67], v[108:123]
    buffer_load_dwordx4 v20, s[32:35], s74 offen offset:0 lds
    ds_read_b64_tr_b16 v[86:87], v33 offset:10240
    ds_read_b64_tr_b16 v[88:89], v35 offset:8192
    v_cmp_eq_u32 vcc, 31, v4
    s_nop 1
    v_cndmask_b32 v5, v5, 30, vcc
    s_waitcnt lgkmcnt(4)
    v_mfma_f32_32x32x16_bf16 v[124:139], v[48:51], v[60:63], v[124:139]
    ds_read_b64_tr_b16 v[90:91], v35 offset:10240
    ds_read_b128 v[72:75], v249 offset:36864
    v_lshrrev_b32 v4, 5, v1
    v_mfma_f32_32x32x16_bf16 v[140:155], v[48:51], v[64:67], v[140:155]
    buffer_load_dwordx4 v21, s[32:35], s74 offen offset:1024 lds
    ds_read_b128 v[76:79], v249 offset:40960
    ds_read_b128 v[80:83], v249 offset:45056
    v_lshlrev_b32 v6, 9, v4
    v_mfma_f32_32x32x16_bf16 v[156:171], v[52:55], v[60:63], v[156:171]
    v_lshl_add_u32 v38, v5, 2, v6
    v_mfma_f32_32x32x16_bf16 v[172:187], v[52:55], v[64:67], v[172:187]
    buffer_load_dwordx4 v22, s[32:35], s74 offen offset:2048 lds
    v_cmp_eq_u32 vcc, 1, v4
    v_mfma_f32_32x32x16_bf16 v[188:203], v[56:59], v[60:63], v[188:203]
    v_mov_b32 v6, 1073741824
    v_mfma_f32_32x32x16_bf16 v[204:219], v[56:59], v[64:67], v[204:219]
    buffer_load_dwordx4 v23, s[32:35], s74 offen offset:3072 lds
    s_waitcnt lgkmcnt(3)
    v_mfma_f32_32x32x16_bf16 v[92:107], v[68:71], v[84:87], v[92:107]
    ds_read_b128 v[44:47], v250 offset:32768
    ds_read_b64_tr_b16 v[60:61], v33 offset:16384
    s_lshl_b32 s87, s71, 2
    s_add_u32 m0, s7, 86016
    v_mfma_f32_32x32x16_bf16 v[108:123], v[68:71], v[88:91], v[108:123]
    buffer_load_dwordx4 v20, s[32:35], s75 offen offset:0 lds
    ds_read_b64_tr_b16 v[62:63], v33 offset:18432
    ds_read_b64_tr_b16 v[64:65], v35 offset:16384
    s_add_u32 s87, s87, s70
    s_waitcnt lgkmcnt(4)
    v_mfma_f32_32x32x16_bf16 v[124:139], v[72:75], v[84:87], v[124:139]
    ds_read_b64_tr_b16 v[66:67], v35 offset:18432
    ds_read_b128 v[48:51], v250 offset:36864
    v_cndmask_b32 v39, v38, v6, vcc
    v_mfma_f32_32x32x16_bf16 v[140:155], v[72:75], v[88:91], v[140:155]
    buffer_load_dwordx4 v21, s[32:35], s75 offen offset:1024 lds
    ds_read_b128 v[52:55], v250 offset:40960
    ds_read_b128 v[56:59], v250 offset:45056
    s_mul_i32 s87, s87, 3584
    v_mfma_f32_32x32x16_bf16 v[156:171], v[76:79], v[84:87], v[156:171]
    s_add_u32 s86, s87, 9437184
    v_mfma_f32_32x32x16_bf16 v[172:187], v[76:79], v[88:91], v[172:187]
    buffer_load_dwordx4 v22, s[32:35], s75 offen offset:2048 lds
    s_lshl_b32 s65, s71, 8
    v_mfma_f32_32x32x16_bf16 v[188:203], v[80:83], v[84:87], v[188:203]
    s_add_u32 s65, s65, 9576448
    v_mfma_f32_32x32x16_bf16 v[204:219], v[80:83], v[88:91], v[204:219]
    buffer_load_dwordx4 v23, s[32:35], s75 offen offset:3072 lds
    s_waitcnt lgkmcnt(3)
    v_mfma_f32_32x32x16_bf16 v[92:107], v[44:47], v[60:63], v[92:107]
    ds_read_b128 v[68:71], v251 offset:32768
    ds_read_b64_tr_b16 v[84:85], v33 offset:24576
    s_add_u32 s13, s84, 0
    v_mfma_f32_32x32x16_bf16 v[108:123], v[44:47], v[64:67], v[108:123]
    ds_read_b64_tr_b16 v[86:87], v33 offset:26624
    ds_read_b64_tr_b16 v[88:89], v35 offset:24576
    s_add_u32 s14, s84, 4096
    s_waitcnt lgkmcnt(4)
    s_nop 0
    v_mfma_f32_32x32x16_bf16 v[124:139], v[48:51], v[60:63], v[124:139]
    ds_read_b64_tr_b16 v[90:91], v35 offset:26624
    ds_read_b128 v[72:75], v251 offset:36864
    s_add_u32 s15, s84, 8192
    v_mfma_f32_32x32x16_bf16 v[140:155], v[48:51], v[64:67], v[140:155]
    ds_read_b128 v[76:79], v251 offset:40960
    ds_read_b128 v[80:83], v251 offset:45056
    s_add_u32 s16, s84, 12288
    v_mfma_f32_32x32x16_bf16 v[156:171], v[52:55], v[60:63], v[156:171]
    s_add_u32 s17, s84, 16384
    v_mfma_f32_32x32x16_bf16 v[172:187], v[52:55], v[64:67], v[172:187]
    s_add_u32 s18, s84, 20480
    v_mfma_f32_32x32x16_bf16 v[188:203], v[56:59], v[60:63], v[188:203]
    s_add_u32 s19, s84, 24576
    v_mfma_f32_32x32x16_bf16 v[204:219], v[56:59], v[64:67], v[204:219]
    s_lshl_b32 s22, s2, 2
    s_add_u32 s22, s22, s70
    s_lshl_b32 s22, s22, 11
    s_cmp_lt_u32 s22, 1605632
    s_cselect_b32 s8, s52, s56
    s_cselect_b32 s9, s53, s57
    s_mov_b32 s10, 401408
    s_cselect_b32 s10, 1605632, s10
    s_cselect_b32 s23, 0, 1605632
    s_mov_b32 s11, 0x20000
    s_sub_u32 s12, s22, s23
    v_and_b32 v255, 15, v1
    v_lshlrev_b32 v255, 7, v255
    buffer_load_dword v254, v255, s[8:11], s12 offen
    s_waitcnt vmcnt(13) lgkmcnt(0)
    s_barrier
    v_mfma_f32_32x32x16_bf16 v[92:107], v[68:71], v[84:87], v[92:107]
    ds_read_b128 v[44:47], v248 offset:0
    ds_read_b64_tr_b16 v[60:61], v32 offset:0
    s_lshl_b32 s73, s72, 7
    s_add_u32 s73, s73, s43
    s_mul_i32 s74, s72, 172032
    s_add_u32 s75, s74, 21504
    s_add_u32 s72, s72, 1
    s_cmp_eq_u32 s72, 7
    s_cselect_b32 s72, 0, s72
    s_cmp_lg_u32 s70, 0
    s_cbranch_scc1 EP_13
    s_lshl_b32 s87, s71, 8
    s_lshl_b32 s89, s68, 2
    s_add_u32 s87, s87, s89
    s_add_u32 s87, s87, 9576448
    v_mov_b32 v4, s3
    s_mov_b64 exec, 1
    buffer_store_dword v4, off, s[44:47], s87 sc1
    s_mov_b64 exec, -1
EP_13:
    s_nop 0
    s_add_u32 m0, s6, 32768
    v_mfma_f32_32x32x16_bf16 v[108:123], v[68:71], v[88:91], v[108:123]
    buffer_load_dwordx4 v16, s[28:31], s73 offen offset:0 lds
    ds_read_b64_tr_b16 v[62:63], v32 offset:2048
    ds_read_b64_tr_b16 v[64:65], v34 offset:0
    v_mfma_f32_32x32x16_bf16 v[124:139], v[72:75], v[84:87], v[124:139]
    ds_read_b64_tr_b16 v[66:67], v34 offset:2048
    ds_read_b128 v[48:51], v248 offset:4096
    v_mfma_f32_32x32x16_bf16 v[140:155], v[72:75], v[88:91], v[140:155]
    buffer_load_dwordx4 v17, s[28:31], s73 offen offset:1024 lds
    ds_read_b128 v[52:55], v248 offset:8192
    ds_read_b128 v[56:59], v248 offset:12288
    v_mfma_f32_32x32x16_bf16 v[156:171], v[76:79], v[84:87], v[156:171]
    v_mfma_f32_32x32x16_bf16 v[172:187], v[76:79], v[88:91], v[172:187]
    buffer_load_dwordx4 v252, s[28:31], s73 offen offset:2048 lds
    v_mfma_f32_32x32x16_bf16 v[188:203], v[80:83], v[84:87], v[188:203]
    v_mfma_f32_32x32x16_bf16 v[204:219], v[80:83], v[88:91], v[204:219]
    buffer_load_dwordx4 v253, s[28:31], s73 offen offset:3072 lds
    s_waitcnt lgkmcnt(3)
    v_mfma_f32_32x32x16_bf16 v[92:107], v[44:47], v[60:63], v[92:107]
    ds_read_b128 v[68:71], v249 offset:0
    ds_read_b64_tr_b16 v[84:85], v32 offset:8192
    s_add_u32 m0, s7, 114688
    v_mfma_f32_32x32x16_bf16 v[108:123], v[44:47], v[64:67], v[108:123]
    buffer_load_dwordx4 v20, s[32:35], s74 offen offset:0 lds
    ds_read_b64_tr_b16 v[86:87], v32 offset:10240
    ds_read_b64_tr_b16 v[88:89], v34 offset:8192
    s_waitcnt lgkmcnt(4)
    v_mfma_f32_32x32x16_bf16 v[124:139], v[48:51], v[60:63], v[124:139]
    ds_read_b64_tr_b16 v[90:91], v34 offset:10240
    ds_read_b128 v[72:75], v249 offset:4096
    v_mfma_f32_32x32x16_bf16 v[140:155], v[48:51], v[64:67], v[140:155]
    buffer_load_dwordx4 v21, s[32:35], s74 offen offset:1024 lds
    ds_read_b128 v[76:79], v249 offset:8192
    ds_read_b128 v[80:83], v249 offset:12288
    v_mfma_f32_32x32x16_bf16 v[156:171], v[52:55], v[60:63], v[156:171]
    v_mfma_f32_32x32x16_bf16 v[172:187], v[52:55], v[64:67], v[172:187]
    buffer_load_dwordx4 v22, s[32:35], s74 offen offset:2048 lds
    v_mfma_f32_32x32x16_bf16 v[188:203], v[56:59], v[60:63], v[188:203]
    v_mfma_f32_32x32x16_bf16 v[204:219], v[56:59], v[64:67], v[204:219]
    buffer_load_dwordx4 v23, s[32:35], s74 offen offset:3072 lds
    s_waitcnt lgkmcnt(3)
    v_mfma_f32_32x32x16_bf16 v[92:107], v[68:71], v[84:87], v[92:107]
    ds_read_b128 v[44:47], v250 offset:0
    ds_read_b64_tr_b16 v[60:61], v32 offset:16384
    s_add_u32 m0, s7, 118784
    v_mfma_f32_32x32x16_bf16 v[108:123], v[68:71], v[88:91], v[108:123]
    buffer_load_dwordx4 v20, s[32:35], s75 offen offset:0 lds
    ds_read_b64_tr_b16 v[62:63], v32 offset:18432
    ds_read_b64_tr_b16 v[64:65], v34 offset:16384
    s_waitcnt lgkmcnt(4)
    v_mfma_f32_32x32x16_bf16 v[124:139], v[72:75], v[84:87], v[124:139]
    ds_read_b64_tr_b16 v[66:67], v34 offset:18432
    ds_read_b128 v[48:51], v250 offset:4096
    v_mfma_f32_32x32x16_bf16 v[140:155], v[72:75], v[88:91], v[140:155]
    buffer_load_dwordx4 v21, s[32:35], s75 offen offset:1024 lds
    ds_read_b128 v[52:55], v250 offset:8192
    ds_read_b128 v[56:59], v250 offset:12288
    v_mfma_f32_32x32x16_bf16 v[156:171], v[76:79], v[84:87], v[156:171]
    v_mfma_f32_32x32x16_bf16 v[172:187], v[76:79], v[88:91], v[172:187]
    buffer_load_dwordx4 v22, s[32:35], s75 offen offset:2048 lds
    v_mfma_f32_32x32x16_bf16 v[188:203], v[80:83], v[84:87], v[188:203]
    v_mfma_f32_32x32x16_bf16 v[204:219], v[80:83], v[88:91], v[204:219]
    buffer_load_dwordx4 v23, s[32:35], s75 offen offset:3072 lds
    s_waitcnt lgkmcnt(3)
    v_mfma_f32_32x32x16_bf16 v[92:107], v[44:47], v[60:63], v[92:107]
    ds_read_b128 v[68:71], v251 offset:0
    ds_read_b64_tr_b16 v[84:85], v32 offset:24576
    v_mfma_f32_32x32x16_bf16 v[108:123], v[44:47], v[64:67], v[108:123]
    ds_read_b64_tr_b16 v[86:87], v32 offset:26624
    ds_read_b64_tr_b16 v[88:89], v34 offset:24576
    s_waitcnt lgkmcnt(4)
    v_mfma_f32_32x32x16_bf16 v[124:139], v[48:51], v[60:63], v[124:139]
    ds_read_b64_tr_b16 v[90:91], v34 offset:26624
    ds_read_b128 v[72:75], v251 offset:4096
    v_mfma_f32_32x32x16_bf16 v[140:155], v[48:51], v[64:67], v[140:155]
    ds_read_b128 v[76:79], v251 offset:8192
    ds_read_b128 v[80:83], v251 offset:12288
    v_mfma_f32_32x32x16_bf16 v[156:171], v[52:55], v[60:63], v[156:171]
    v_mfma_f32_32x32x16_bf16 v[172:187], v[52:55], v[64:67], v[172:187]
    v_mfma_f32_32x32x16_bf16 v[188:203], v[56:59], v[60:63], v[188:203]
    v_mfma_f32_32x32x16_bf16 v[204:219], v[56:59], v[64:67], v[204:219]
    s_waitcnt vmcnt(13) lgkmcnt(0)
    s_barrier
    v_mfma_f32_32x32x16_bf16 v[92:107], v[68:71], v[84:87], v[92:107]
    ds_read_b128 v[44:47], v248 offset:16384
    ds_read_b64_tr_b16 v[60:61], v32 offset:32768
    s_lshl_b32 s73, s72, 7
    s_add_u32 s73, s73, s43
    s_mul_i32 s74, s72, 172032
    s_add_u32 s75, s74, 21504
    s_add_u32 s72, s72, 1
    s_cmp_eq_u32 s72, 7
    s_cselect_b32 s72, 0, s72
    s_add_u32 m0, s6, 0
    v_mfma_f32_32x32x16_bf16 v[108:123], v[68:71], v[88:91], v[108:123]
    buffer_load_dwordx4 v16, s[28:31], s73 offen offset:0 lds
    ds_read_b64_tr_b16 v[62:63], v32 offset:34816
    ds_read_b64_tr_b16 v[64:65], v34 offset:32768
    v_mfma_f32_32x32x16_bf16 v[124:139], v[72:75], v[84:87], v[124:139]
    ds_read_b64_tr_b16 v[66:67], v34 offset:34816
    ds_read_b128 v[48:51], v248 offset:20480
    v_mfma_f32_32x32x16_bf16 v[140:155], v[72:75], v[88:91], v[140:155]
    buffer_load_dwordx4 v17, s[28:31], s73 offen offset:1024 lds
    ds_read_b128 v[52:55], v248 offset:24576
    ds_read_b128 v[56:59], v248 offset:28672
    v_mfma_f32_32x32x16_bf16 v[156:171], v[76:79], v[84:87], v[156:171]
    v_mfma_f32_32x32x16_bf16 v[172:187], v[76:79], v[88:91], v[172:187]
    buffer_load_dwordx4 v252, s[28:31], s73 offen offset:2048 lds
    v_mfma_f32_32x32x16_bf16 v[188:203], v[80:83], v[84:87], v[188:203]
    v_mfma_f32_32x32x16_bf16 v[204:219], v[80:83], v[88:91], v[204:219]
    buffer_load_dwordx4 v253, s[28:31], s73 offen offset:3072 lds
    s_waitcnt lgkmcnt(3)
    v_mfma_f32_32x32x16_bf16 v[92:107], v[44:47], v[60:63], v[92:107]
    ds_read_b128 v[68:71], v249 offset:16384
    ds_read_b64_tr_b16 v[84:85], v32 offset:40960
    s_add_u32 m0, s7, 49152
    v_mfma_f32_32x32x16_bf16 v[108:123], v[44:47], v[64:67], v[108:123]
    buffer_load_dwordx4 v20, s[32:35], s74 offen offset:0 lds
    ds_read_b64_tr_b16 v[86:87], v32 offset:43008
    ds_read_b64_tr_b16 v[88:89], v34 offset:40960
    s_waitcnt lgkmcnt(4)
    v_mfma_f32_32x32x16_bf16 v[124:139], v[48:51], v[60:63], v[124:139]
    ds_read_b64_tr_b16 v[90:91], v34 offset:43008
    ds_read_b128 v[72:75], v249 offset:20480
    v_mfma_f32_32x32x16_bf16 v[140:155], v[48:51], v[64:67], v[140:155]
    buffer_load_dwordx4 v21, s[32:35], s74 offen offset:1024 lds
    ds_read_b128 v[76:79], v249 offset:24576
    ds_read_b128 v[80:83], v249 offset:28672
    v_mfma_f32_32x32x16_bf16 v[156:171], v[52:55], v[60:63], v[156:171]
    v_mfma_f32_32x32x16_bf16 v[172:187], v[52:55], v[64:67], v[172:187]
    buffer_load_dwordx4 v22, s[32:35], s74 offen offset:2048 lds
    v_mfma_f32_32x32x16_bf16 v[188:203], v[56:59], v[60:63], v[188:203]
    v_mfma_f32_32x32x16_bf16 v[204:219], v[56:59], v[64:67], v[204:219]
    buffer_load_dwordx4 v23, s[32:35], s74 offen offset:3072 lds
    s_waitcnt lgkmcnt(3)
    v_mfma_f32_32x32x16_bf16 v[92:107], v[68:71], v[84:87], v[92:107]
    ds_read_b128 v[44:47], v250 offset:16384
    ds_read_b64_tr_b16 v[60:61], v32 offset:49152
    s_add_u32 m0, s7, 53248
    v_mfma_f32_32x32x16_bf16 v[108:123], v[68:71], v[88:91], v[108:123]
    buffer_load_dwordx4 v20, s[32:35], s75 offen offset:0 lds
    ds_read_b64_tr_b16 v[62:63], v32 offset:51200
    ds_read_b64_tr_b16 v[64:65], v34 offset:49152
    s_waitcnt lgkmcnt(4)
    v_mfma_f32_32x32x16_bf16 v[124:139], v[72:75], v[84:87], v[124:139]
    ds_read_b64_tr_b16 v[66:67], v34 offset:51200
    ds_read_b128 v[48:51], v250 offset:20480
    v_mfma_f32_32x32x16_bf16 v[140:155], v[72:75], v[88:91], v[140:155]
    buffer_load_dwordx4 v21, s[32:35], s75 offen offset:1024 lds
    ds_read_b128 v[52:55], v250 offset:24576
    ds_read_b128 v[56:59], v250 offset:28672
    v_mfma_f32_32x32x16_bf16 v[156:171], v[76:79], v[84:87], v[156:171]
    v_mfma_f32_32x32x16_bf16 v[172:187], v[76:79], v[88:91], v[172:187]
    buffer_load_dwordx4 v22, s[32:35], s75 offen offset:2048 lds
    v_mfma_f32_32x32x16_bf16 v[188:203], v[80:83], v[84:87], v[188:203]
    v_mfma_f32_32x32x16_bf16 v[204:219], v[80:83], v[88:91], v[204:219]
    buffer_load_dwordx4 v23, s[32:35], s75 offen offset:3072 lds
    s_waitcnt lgkmcnt(3)
    v_mfma_f32_32x32x16_bf16 v[92:107], v[44:47], v[60:63], v[92:107]
    ds_read_b128 v[68:71], v251 offset:16384
    ds_read_b64_tr_b16 v[84:85], v32 offset:57344
    s_mov_b32 s94, 0x3fb8aa3b
    v_mfma_f32_32x32x16_bf16 v[108:123], v[44:47], v[64:67], v[108:123]
    ds_read_b64_tr_b16 v[86:87], v32 offset:59392
    ds_read_b64_tr_b16 v[88:89], v34 offset:57344
    s_waitcnt lgkmcnt(4)
    v_mfma_f32_32x32x16_bf16 v[124:139], v[48:51], v[60:63], v[124:139]
    ds_read_b64_tr_b16 v[90:91], v34 offset:59392
    ds_read_b128 v[72:75], v251 offset:20480
    s_mov_b32 s95, 0x3fb8aa3b
    v_mfma_f32_32x32x16_bf16 v[140:155], v[48:51], v[64:67], v[140:155]
    ds_read_b128 v[76:79], v251 offset:24576
    ds_read_b128 v[80:83], v251 offset:28672
    v_mfma_f32_32x32x16_bf16 v[156:171], v[52:55], v[60:63], v[156:171]
    s_mov_b32 s98, s93
    v_mfma_f32_32x32x16_bf16 v[172:187], v[52:55], v[64:67], v[172:187]
    v_mfma_f32_32x32x16_bf16 v[188:203], v[56:59], v[60:63], v[188:203]
    s_mov_b32 s99, s93
    v_mfma_f32_32x32x16_bf16 v[204:219], v[56:59], v[64:67], v[204:219]
    s_waitcnt vmcnt(12) lgkmcnt(0)
    s_barrier
    v_mfma_f32_32x32x16_bf16 v[92:107], v[68:71], v[84:87], v[92:107]
    ds_read_b128 v[44:47], v248 offset:32768
    ds_read_b64_tr_b16 v[60:61], v33 offset:0
    v_lshrrev_b32 v4, 3, v1
    v_mul_u32_u24 v4, 896, v4
    v_mfma_f32_32x32x16_bf16 v[108:123], v[68:71], v[88:91], v[108:123]
    ds_read_b64_tr_b16 v[62:63], v33 offset:2048
    ds_read_b64_tr_b16 v[64:65], v35 offset:0
    v_bfe_u32 v5, v1, 4, 1
    v_mfma_f32_32x32x16_bf16 v[124:139], v[72:75], v[84:87], v[124:139]
    ds_read_b64_tr_b16 v[66:67], v35 offset:2048
    ds_read_b128 v[48:51], v248 offset:36864
    v_lshlrev_b32 v5, 2, v5
    v_and_b32 v6, 7, v1
    v_mfma_f32_32x32x16_bf16 v[140:155], v[72:75], v[88:91], v[140:155]
    ds_read_b128 v[52:55], v248 offset:40960
    ds_read_b128 v[56:59], v248 offset:45056
    v_xor_b32 v5, v5, v6
    v_mfma_f32_32x32x16_bf16 v[156:171], v[76:79], v[84:87], v[156:171]
    s_lshl_b32 s87, s78, 7
    v_mfma_f32_32x32x16_bf16 v[172:187], v[76:79], v[88:91], v[172:187]
    v_lshl_add_u32 v12, v5, 4, v4
    v_add_u32 v12, s87, v12
    v_mfma_f32_32x32x16_bf16 v[188:203], v[80:83], v[84:87], v[188:203]
    v_add_u32 v13, 6144, v12
    v_mfma_f32_32x32x16_bf16 v[204:219], v[80:83], v[88:91], v[204:219]
    v_add_u32 v14, 12288, v12
    s_waitcnt lgkmcnt(3)
    v_mfma_f32_32x32x16_bf16 v[92:107], v[44:47], v[60:63], v[92:107]
    ds_read_b128 v[68:71], v249 offset:32768
    ds_read_b64_tr_b16 v[84:85], v33 offset:8192
    v_add_u32 v15, 18432, v12
    s_mul_i32 s73, s70, 401408
    v_mfma_f32_32x32x16_bf16 v[108:123], v[44:47], v[64:67], v[108:123]
    ds_read_b64_tr_b16 v[86:87], v33 offset:10240
    ds_read_b64_tr_b16 v[88:89], v35 offset:8192
    s_mul_i32 s75, s70, 100352
    s_waitcnt lgkmcnt(4)
    v_mfma_f32_32x32x16_bf16 v[124:139], v[48:51], v[60:63], v[124:139]
    buffer_load_dwordx4 v[8:11], v18, s[44:47], s40 offen sc1
    ds_read_b64_tr_b16 v[90:91], v35 offset:10240
    ds_read_b128 v[72:75], v249 offset:36864
    s_mul_i32 s74, s70, 20480
    s_add_u32 s74, s74, 61440
    v_mfma_f32_32x32x16_bf16 v[140:155], v[48:51], v[64:67], v[140:155]
    ds_read_b128 v[76:79], v249 offset:40960
    ds_read_b128 v[80:83], v249 offset:45056
    s_lshl_b32 s20, s70, 14
    v_mfma_f32_32x32x16_bf16 v[156:171], v[52:55], v[60:63], v[156:171]
    buffer_load_dwordx4 v[220:223], v26, s[44:47], s13 offen sc1
    s_add_u32 s20, s20, 20480
    v_mfma_f32_32x32x16_bf16 v[172:187], v[52:55], v[64:67], v[172:187]
    s_cmp_eq_u32 s70, 0
    s_cselect_b32 s74, 16384, s74
    s_cselect_b32 s20, 0, s20
    s_cmp_eq_u32 s70, 3
    s_cselect_b32 s20, 143360, s20
    v_mfma_f32_32x32x16_bf16 v[188:203], v[56:59], v[60:63], v[188:203]
    buffer_load_dwordx4 v[224:227], v26, s[44:47], s14 offen sc1
    s_mul_i32 s87, s77, 286720
    v_mfma_f32_32x32x16_bf16 v[204:219], v[56:59], v[64:67], v[204:219]
    s_mul_i32 s88, s70, 7168
    s_waitcnt lgkmcnt(3)
    v_mfma_f32_32x32x16_bf16 v[92:107], v[68:71], v[84:87], v[92:107]
    ds_read_b128 v[44:47], v250 offset:32768
    ds_read_b64_tr_b16 v[60:61], v33 offset:16384
    s_add_u32 s48, s87, s88
    s_add_u32 s49, s48, 143360
    v_mfma_f32_32x32x16_bf16 v[108:123], v[68:71], v[88:91], v[108:123]
    ds_read_b64_tr_b16 v[62:63], v33 offset:18432
    ds_read_b64_tr_b16 v[64:65], v35 offset:16384
    s_lshl2_add_u32 s87, s88, s87
    s_waitcnt lgkmcnt(4)
    v_mfma_f32_32x32x16_bf16 v[124:139], v[72:75], v[84:87], v[124:139]
    buffer_load_dwordx4 v[228:231], v26, s[44:47], s15 offen sc1
    ds_read_b64_tr_b16 v[66:67], v35 offset:18432
    ds_read_b128 v[48:51], v250 offset:36864
    s_add_u32 s32, s87, 28672
    s_add_u32 s39, s87, 172032
    v_mfma_f32_32x32x16_bf16 v[140:155], v[72:75], v[88:91], v[140:155]
    ds_read_b128 v[52:55], v250 offset:40960
    ds_read_b128 v[56:59], v250 offset:45056
    s_add_u32 s33, s87, 32768
    v_mfma_f32_32x32x16_bf16 v[156:171], v[76:79], v[84:87], v[156:171]
    buffer_load_dwordx4 v[232:235], v26, s[44:47], s16 offen sc1
    s_add_u32 s21, s87, 176128
    v_mfma_f32_32x32x16_bf16 v[172:187], v[76:79], v[88:91], v[172:187]
    s_add_u32 s34, s87, 36864
    s_add_u32 s24, s87, 180224
    v_mfma_f32_32x32x16_bf16 v[188:203], v[80:83], v[84:87], v[188:203]
    buffer_load_dwordx4 v[236:239], v26, s[44:47], s17 offen sc1
    s_add_u32 s35, s87, 40960
    v_mfma_f32_32x32x16_bf16 v[204:219], v[80:83], v[88:91], v[204:219]
    s_add_u32 s25, s87, 184320
    s_waitcnt lgkmcnt(3)
    s_nop 0
    v_mfma_f32_32x32x16_bf16 v[92:107], v[44:47], v[60:63], v[92:107]
    ds_read_b128 v[68:71], v251 offset:32768
    ds_read_b64_tr_b16 v[84:85], v33 offset:24576
    s_add_u32 s36, s87, 45056
    s_add_u32 s72, s87, 188416
    v_mfma_f32_32x32x16_bf16 v[108:123], v[44:47], v[64:67], v[108:123]
    ds_read_b64_tr_b16 v[86:87], v33 offset:26624
    ds_read_b64_tr_b16 v[88:89], v35 offset:24576
    s_add_u32 s37, s87, 49152
    s_add_u32 s83, s87, 192512
    s_waitcnt lgkmcnt(4)
    s_nop 0
    v_mfma_f32_32x32x16_bf16 v[124:139], v[48:51], v[60:63], v[124:139]
    buffer_load_dwordx4 v[240:243], v26, s[44:47], s18 offen sc1
    ds_read_b64_tr_b16 v[90:91], v35 offset:26624
    ds_read_b128 v[72:75], v251 offset:36864
    s_add_u32 s38, s87, 53248
    v_mfma_f32_32x32x16_bf16 v[140:155], v[48:51], v[64:67], v[140:155]
    ds_read_b128 v[76:79], v251 offset:40960
    ds_read_b128 v[80:83], v251 offset:45056
    s_add_u32 s85, s87, 196608
    s_mul_i32 s50, s70, 14336
    v_mfma_f32_32x32x16_bf16 v[156:171], v[52:55], v[60:63], v[156:171]
    buffer_load_dwordx4 v[244:247], v26, s[44:47], s19 offen sc1
    s_add_u32 s50, s50, 9437184
    s_lshr_b32 s87, s77, 1
    v_mfma_f32_32x32x16_bf16 v[172:187], v[52:55], v[64:67], v[172:187]
    s_lshl_b32 s88, s87, 8
    v_mfma_f32_32x32x16_bf16 v[188:203], v[56:59], v[60:63], v[188:203]
    buffer_load_dword v19, v2, s[44:47], s65 offen sc1
    s_add_u32 s43, s88, 9568256
    s_add_u32 s51, s88, 9572352
    v_mfma_f32_32x32x16_bf16 v[204:219], v[56:59], v[64:67], v[204:219]
    s_getpc_b64 s[10:11]
L_c2k:
    s_mul_i32 s12, s70, 2048
    v_min_u32 v255, 15, v1
    v_lshl_add_u32 v255, v255, 7, s12
    v_min_u32 v255, L_end-L_c2k-4, v255
    global_load_dword v254, v255, s[10:11]
    s_waitcnt vmcnt(10) lgkmcnt(0)
    s_barrier
    v_mfma_f32_32x32x16_bf16 v[92:107], v[68:71], v[84:87], v[92:107]
    ds_read_b128 v[44:47], v248 offset:0
    ds_read_b64_tr_b16 v[60:61], v32 offset:0
    v_lshrrev_b32 v4, 5, v1
    v_mfma_f32_32x32x16_bf16 v[108:123], v[68:71], v[88:91], v[108:123]
    ds_read_b64_tr_b16 v[62:63], v32 offset:2048
    ds_read_b64_tr_b16 v[64:65], v34 offset:0
    v_bfe_u32 v5, v1, 2, 2
    v_mfma_f32_32x32x16_bf16 v[124:139], v[72:75], v[84:87], v[124:139]
    s_add_u32 m0, s74, 0
    s_add_u32 s76, s73, 0
    s_nop 0
    buffer_load_dwordx4 v12, s[52:55], s76 offen offset:0 lds
    ds_read_b64_tr_b16 v[66:67], v34 offset:2048
    ds_read_b128 v[48:51], v248 offset:4096
    v_lshl_add_u32 v6, v4, 2, v5
    v_mfma_f32_32x32x16_bf16 v[140:155], v[72:75], v[88:91], v[140:155]
    ds_read_b128 v[52:55], v248 offset:8192
    ds_read_b128 v[56:59], v248 offset:12288
    v_bfe_u32 v7, v1, 4, 1
    v_mfma_f32_32x32x16_bf16 v[156:171], v[76:79], v[84:87], v[156:171]
    buffer_load_dwordx4 v13, s[52:55], s76 offen offset:1024 lds
    v_lshlrev_b32 v7, 5, v7
    v_mfma_f32_32x32x16_bf16 v[172:187], v[76:79], v[88:91], v[172:187]
    v_and_b32 v4, 3, v1
    v_mfma_f32_32x32x16_bf16 v[188:203], v[80:83], v[84:87], v[188:203]
    buffer_load_dwordx4 v14, s[52:55], s76 offen offset:2048 lds
    v_lshl_add_u32 v7, v4, 3, v7
    v_mfma_f32_32x32x16_bf16 v[204:219], v[80:83], v[88:91], v[204:219]
    s_waitcnt lgkmcnt(3)
    v_mfma_f32_32x32x16_bf16 v[92:107], v[44:47], v[60:63], v[92:107]
    ds_read_b128 v[68:71], v249 offset:0
    ds_read_b64_tr_b16 v[84:85], v32 offset:8192
    v_bfe_u32 v4, v1, 3, 1
    v_mfma_f32_32x32x16_bf16 v[108:123], v[44:47], v[64:67], v[108:123]
    ds_read_b64_tr_b16 v[86:87], v32 offset:10240
    ds_read_b64_tr_b16 v[88:89], v34 offset:8192
    v_lshlrev_b32 v4, 6, v4
    s_waitcnt lgkmcnt(4)
    v_mfma_f32_32x32x16_bf16 v[124:139], v[48:51], v[60:63], v[124:139]
    buffer_load_dwordx4 v15, s[52:55], s76 offen offset:3072 lds
    ds_read_b64_tr_b16 v[90:91], v34 offset:10240
    ds_read_b128 v[72:75], v249 offset:4096
    v_xor_b32 v4, v7, v4
    v_mfma_f32_32x32x16_bf16 v[140:155], v[48:51], v[64:67], v[140:155]
    ds_read_b128 v[76:79], v249 offset:8192
    ds_read_b128 v[80:83], v249 offset:12288
    v_lshl_add_u32 v4, v6, 7, v4
    v_mfma_f32_32x32x16_bf16 v[156:171], v[52:55], v[60:63], v[156:171]
    s_add_u32 m0, s74, 4096
    s_add_u32 s76, s73, 28672
    buffer_load_dwordx4 v12, s[52:55], s76 offen offset:0 lds
    v_add_u32 v252, s74, v4
    v_mfma_f32_32x32x16_bf16 v[172:187], v[52:55], v[64:67], v[172:187]
    v_xor_b32 v253, 64, v252
    v_mfma_f32_32x32x16_bf16 v[188:203], v[56:59], v[60:63], v[188:203]
    buffer_load_dwordx4 v13, s[52:55], s76 offen offset:1024 lds
    v_add_u32 v16, s20, v4
    v_mfma_f32_32x32x16_bf16 v[204:219], v[56:59], v[64:67], v[204:219]
    v_xor_b32 v17, 64, v16
    s_waitcnt lgkmcnt(3)
    v_mfma_f32_32x32x16_bf16 v[92:107], v[68:71], v[84:87], v[92:107]
    ds_read_b128 v[44:47], v250 offset:0
    ds_read_b64_tr_b16 v[60:61], v32 offset:16384
    v_mfma_f32_32x32x16_bf16 v[108:123], v[68:71], v[88:91], v[108:123]
    ds_read_b64_tr_b16 v[62:63], v32 offset:18432
    ds_read_b64_tr_b16 v[64:65], v34 offset:16384
    s_waitcnt lgkmcnt(4)
    v_mfma_f32_32x32x16_bf16 v[124:139], v[72:75], v[84:87], v[124:139]
    buffer_load_dwordx4 v14, s[52:55], s76 offen offset:2048 lds
    ds_read_b64_tr_b16 v[66:67], v34 offset:18432
    ds_read_b128 v[48:51], v250 offset:4096
    v_mfma_f32_32x32x16_bf16 v[140:155], v[72:75], v[88:91], v[140:155]
    ds_read_b128 v[52:55], v250 offset:8192
    ds_read_b128 v[56:59], v250 offset:12288
    v_mfma_f32_32x32x16_bf16 v[156:171], v[76:79], v[84:87], v[156:171]
    buffer_load_dwordx4 v15, s[52:55], s76 offen offset:3072 lds
    v_mfma_f32_32x32x16_bf16 v[172:187], v[76:79], v[88:91], v[172:187]
    v_mfma_f32_32x32x16_bf16 v[188:203], v[80:83], v[84:87], v[188:203]
    s_add_u32 m0, s74, 8192
    s_add_u32 s76, s73, 57344
    buffer_load_dwordx4 v12, s[52:55], s76 offen offset:0 lds
    v_mfma_f32_32x32x16_bf16 v[204:219], v[80:83], v[88:91], v[204:219]
    s_waitcnt lgkmcnt(3)
    v_mfma_f32_32x32x16_bf16 v[92:107], v[44:47], v[60:63], v[92:107]
    ds_read_b128 v[68:71], v251 offset:0
    ds_read_b64_tr_b16 v[84:85], v32 offset:24576
    s_waitcnt vmcnt(10)
    v_xor_b32 v40, s3, v9
    v_xor_b32 v41, s3, v11
    v_or_b32 v40, v40, v41
    v_mfma_f32_32x32x16_bf16 v[108:123], v[44:47], v[64:67], v[108:123]
    ds_read_b64_tr_b16 v[86:87], v32 offset:26624
    ds_read_b64_tr_b16 v[88:89], v34 offset:24576
    v_xor_b32 v41, s3, v221
    v_or_b32 v40, v40, v41
    v_xor_b32 v41, s3, v223
    s_waitcnt lgkmcnt(4)
    v_mfma_f32_32x32x16_bf16 v[124:139], v[48:51], v[60:63], v[124:139]
    buffer_load_dwordx4 v13, s[52:55], s76 offen offset:1024 lds
    ds_read_b64_tr_b16 v[90:91], v34 offset:26624
    ds_read_b128 v[72:75], v251 offset:4096
    v_or_b32 v40, v40, v41
    v_xor_b32 v41, s3, v225
    v_or_b32 v40, v40, v41
    v_mfma_f32_32x32x16_bf16 v[140:155], v[48:51], v[64:67], v[140:155]
    ds_read_b128 v[76:79], v251 offset:8192
    ds_read_b128 v[80:83], v251 offset:12288
    v_xor_b32 v41, s3, v227
    v_or_b32 v40, v40, v41
    v_xor_b32 v41, s3, v229
    v_mfma_f32_32x32x16_bf16 v[156:171], v[52:55], v[60:63], v[156:171]
    buffer_load_dwordx4 v14, s[52:55], s76 offen offset:2048 lds
    v_or_b32 v40, v40, v41
    v_xor_b32 v41, s3, v231
    v_or_b32 v40, v40, v41
    v_xor_b32 v41, s3, v233
    v_mfma_f32_32x32x16_bf16 v[172:187], v[52:55], v[64:67], v[172:187]
    v_or_b32 v40, v40, v41
    v_xor_b32 v41, s3, v235
    v_or_b32 v40, v40, v41
    v_mfma_f32_32x32x16_bf16 v[188:203], v[56:59], v[60:63], v[188:203]
    buffer_load_dwordx4 v15, s[52:55], s76 offen offset:3072 lds
    v_xor_b32 v41, s3, v237
    v_or_b32 v40, v40, v41
    v_xor_b32 v41, s3, v239
    v_mfma_f32_32x32x16_bf16 v[204:219], v[56:59], v[64:67], v[204:219]
    v_or_b32 v40, v40, v41
    v_xor_b32 v41, s3, v241
    v_or_b32 v40, v40, v41
    s_waitcnt lgkmcnt(3)
    v_mfma_f32_32x32x16_bf16 v[92:107], v[68:71], v[84:87], v[92:107]
    v_xor_b32 v41, s3, v243
    v_or_b32 v40, v40, v41
    v_xor_b32 v41, s3, v245
    v_or_b32 v40, v40, v41
    v_mfma_f32_32x32x16_bf16 v[108:123], v[68:71], v[88:91], v[108:123]
    v_xor_b32 v41, s3, v247
    v_or_b32 v40, v40, v41
    v_add_f32 v220, v220, v222
    s_waitcnt lgkmcnt(0)
    v_mfma_f32_32x32x16_bf16 v[124:139], v[72:75], v[84:87], v[124:139]
    v_add_f32 v224, v224, v226
    v_add_f32 v228, v228, v230
    v_add_f32 v232, v232, v234
    v_mfma_f32_32x32x16_bf16 v[140:155], v[72:75], v[88:91], v[140:155]
    v_add_f32 v236, v236, v238
    v_add_f32 v240, v240, v242
    v_add_f32 v244, v244, v246
    v_mfma_f32_32x32x16_bf16 v[156:171], v[76:79], v[84:87], v[156:171]
    v_add_f32 v220, v220, v224
    v_add_f32 v220, v220, v228
    v_add_f32 v220, v220, v232
    v_add_f32 v220, v220, v236
    v_mfma_f32_32x32x16_bf16 v[172:187], v[76:79], v[88:91], v[172:187]
    v_add_f32 v220, v220, v240
    v_add_f32 v220, v220, v244
    ds_write_b32 v42, v8
    v_mfma_f32_32x32x16_bf16 v[188:203], v[80:83], v[84:87], v[188:203]
    ds_write_b32 v42, v10 offset:512
    v_mov_b32 v20, v220
    v_mov_b32 v22, v220
    v_mfma_f32_32x32x16_bf16 v[204:219], v[80:83], v[88:91], v[204:219]
    s_nop 0
    v_permlane32_swap_b32 v20, v22
    v_mov_b32 v21, v20
    v_mov_b32 v23, v22
    s_mov_b32 s92, 30000
ST_14:
    v_cmp_eq_u32 vcc, 0, v40
    s_nop 0
    s_cmp_eq_u64 vcc, -1
    s_cbranch_scc1 SK_15
    s_sub_u32 s92, s92, 1
    s_cmp_eq_u32 s92, 0
    s_cbranch_scc1 SK_15
    buffer_load_dwordx4 v[8:11], v18, s[44:47], s40 offen sc1
    buffer_load_dwordx4 v[220:223], v26, s[44:47], s13 offen sc1
    buffer_load_dwordx4 v[224:227], v26, s[44:47], s14 offen sc1
    buffer_load_dwordx4 v[228:231], v26, s[44:47], s15 offen sc1
    buffer_load_dwordx4 v[232:235], v26, s[44:47], s16 offen sc1
    buffer_load_dwordx4 v[236:239], v26, s[44:47], s17 offen sc1
    buffer_load_dwordx4 v[240:243], v26, s[44:47], s18 offen sc1
    buffer_load_dwordx4 v[244:247], v26, s[44:47], s19 offen sc1
    s_waitcnt vmcnt(0)
    v_xor_b32 v40, s3, v9
    v_xor_b32 v41, s3, v11
    v_or_b32 v40, v40, v41
    v_xor_b32 v41, s3, v221
    v_or_b32 v40, v40, v41
    v_xor_b32 v41, s3, v223
    v_or_b32 v40, v40, v41
    v_xor_b32 v41, s3, v225
    v_or_b32 v40, v40, v41
    v_xor_b32 v41, s3, v227
    v_or_b32 v40, v40, v41
    v_xor_b32 v41, s3, v229
    v_or_b32 v40, v40, v41
    v_xor_b32 v41, s3, v231
    v_or_b32 v40, v40, v41
    v_xor_b32 v41, s3, v233
    v_or_b32 v40, v40, v41
    v_xor_b32 v41, s3, v235
    v_or_b32 v40, v40, v41
    v_xor_b32 v41, s3, v237
    v_or_b32 v40, v40, v41
    v_xor_b32 v41, s3, v239
    v_or_b32 v40, v40, v41
    v_xor_b32 v41, s3, v241
    v_or_b32 v40, v40, v41
    v_xor_b32 v41, s3, v243
    v_or_b32 v40, v40, v41
    v_xor_b32 v41, s3, v245
    v_or_b32 v40, v40, v41
    v_xor_b32 v41, s3, v247
    v_or_b32 v40, v40, v41
    v_add_f32 v220, v220, v222
    v_add_f32 v224, v224, v226
    v_add_f32 v228, v228, v230
    v_add_f32 v232, v232, v234
    v_add_f32 v236, v236, v238
    v_add_f32 v240, v240, v242
    v_add_f32 v244, v244, v246
    v_add_f32 v220, v220, v224
    v_add_f32 v220, v220, v228
    v_add_f32 v220, v220, v232
    v_add_f32 v220, v220, v236
    v_add_f32 v220, v220, v240
    v_add_f32 v220, v220, v244
    ds_write_b32 v42, v8
    ds_write_b32 v42, v10 offset:512
    v_mov_b32 v20, v220
    v_mov_b32 v22, v220
    s_nop 1
    v_permlane32_swap_b32 v20, v22
    v_mov_b32 v21, v20
    v_mov_b32 v23, v22
    s_branch ST_14
SK_15:
    s_waitcnt lgkmcnt(0)
    s_barrier
    ds_read_b128 v[44:47], v37 offset:0
    ds_read_b128 v[60:63], v37 offset:512
    ds_read_b128 v[48:51], v37 offset:32
    ds_read_b128 v[64:67], v37 offset:544
    ds_read_b128 v[52:55], v37 offset:64
    ds_read_b128 v[68:71], v37 offset:576
    ds_read_b128 v[56:59], v37 offset:96
    ds_read_b128 v[72:75], v37 offset:608
    v_cmp_eq_u32 vcc, s3, v19
    s_nop 0
    s_cmp_eq_u64 vcc, -1
    s_cbranch_scc1 FK_16
    s_mov_b32 s92, 30000
SP_17:
    buffer_load_dword v19, v2, s[44:47], s65 offen sc1
    s_waitcnt vmcnt(0)
    v_cmp_eq_u32 vcc, s3, v19
    s_nop 0
    s_cmp_eq_u64 vcc, -1
    s_cbranch_scc1 SD_18
    s_sub_u32 s92, s92, 1
    s_cmp_eq_u32 s92, 0
    s_cbranch_scc0 SP_17
SD_18:
FK_16:
    s_waitcnt lgkmcnt(0)
    s_nop 0
    v_pk_fma_f32 v[4:5], v[60:61], v[20:21], s[98:99]
    v_pk_mul_f32 v[6:7], v[60:61], v[22:23]
    v_pk_fma_f32 v[8:9], v[62:63], v[20:21], s[98:99]
    v_pk_mul_f32 v[10:11], v[62:63], v[22:23]
    v_pk_fma_f32 v[92:93], v[92:93], v[44:45], v[4:5]
    ds_read_b128 v[220:223], v37 offset:128
    ds_read_b128 v[236:239], v37 offset:640
    ds_read_b128 v[224:227], v37 offset:160
    ds_read_b128 v[240:243], v37 offset:672
    ds_read_b128 v[228:231], v37 offset:192
    ds_read_b128 v[244:247], v37 offset:704
    ds_read_b128 v[232:235], v37 offset:224
    ds_read_b128 v[248:251], v37 offset:736
    v_pk_fma_f32 v[108:109], v[108:109], v[44:45], v[6:7]
    v_pk_fma_f32 v[94:95], v[94:95], v[46:47], v[8:9]
    v_pk_fma_f32 v[110:111], v[110:111], v[46:47], v[10:11]
    v_pk_mul_f32 v[4:5], v[92:93], s[94:95]
    v_pk_mul_f32 v[8:9], v[94:95], s[94:95]
    v_exp_f32 v4, v4 clamp
    v_exp_f32 v5, v5 clamp
    v_exp_f32 v8, v8 clamp
    v_exp_f32 v9, v9 clamp
    v_cvt_pk_bf16_f32 v108, v108, v109
    v_cvt_pk_bf16_f32 v109, v110, v111
    v_max_f32 v92, s93, v92
    v_max_f32 v93, s93, v93
    v_max_f32 v94, s93, v94
    v_max_f32 v95, s93, v95
    v_cndmask_b32 v108, v108, v36, s[96:97]
    v_cndmask_b32 v109, v109, v36, s[96:97]
    v_pk_add_f32 v[92:93], v[92:93], v[4:5]
    v_pk_add_f32 v[94:95], v[94:95], v[8:9]
    v_cvt_pk_bf16_f32 v92, v92, v93
    v_cvt_pk_bf16_f32 v93, v94, v95
    v_pk_fma_f32 v[4:5], v[64:65], v[20:21], s[98:99]
    v_pk_mul_f32 v[6:7], v[64:65], v[22:23]
    v_pk_fma_f32 v[8:9], v[66:67], v[20:21], s[98:99]
    v_pk_mul_f32 v[10:11], v[66:67], v[22:23]
    v_pk_fma_f32 v[96:97], v[96:97], v[48:49], v[4:5]
    v_pk_fma_f32 v[112:113], v[112:113], v[48:49], v[6:7]
    v_pk_fma_f32 v[98:99], v[98:99], v[50:51], v[8:9]
    v_pk_fma_f32 v[114:115], v[114:115], v[50:51], v[10:11]
    v_pk_mul_f32 v[4:5], v[96:97], s[94:95]
    v_pk_mul_f32 v[8:9], v[98:99], s[94:95]
    s_add_u32 m0, s74, 12288
    s_add_u32 s76, s73, 86016
    buffer_load_dwordx4 v12, s[52:55], s76 offen offset:0 lds
    buffer_load_dwordx4 v13, s[52:55], s76 offen offset:1024 lds
    buffer_load_dwordx4 v14, s[52:55], s76 offen offset:2048 lds
    v_exp_f32 v4, v4 clamp
    v_exp_f32 v5, v5 clamp
    v_exp_f32 v8, v8 clamp
    v_exp_f32 v9, v9 clamp
    v_cvt_pk_bf16_f32 v110, v112, v113
    v_cvt_pk_bf16_f32 v111, v114, v115
    v_max_f32 v96, s93, v96
    v_max_f32 v97, s93, v97
    v_max_f32 v98, s93, v98
    v_max_f32 v99, s93, v99
    v_cndmask_b32 v110, v110, v36, s[96:97]
    v_cndmask_b32 v111, v111, v36, s[96:97]
    v_pk_add_f32 v[96:97], v[96:97], v[4:5]
    v_pk_add_f32 v[98:99], v[98:99], v[8:9]
    v_cvt_pk_bf16_f32 v94, v96, v97
    v_cvt_pk_bf16_f32 v95, v98, v99
    v_pk_fma_f32 v[4:5], v[68:69], v[20:21], s[98:99]
    v_pk_mul_f32 v[6:7], v[68:69], v[22:23]
    v_pk_fma_f32 v[8:9], v[70:71], v[20:21], s[98:99]
    v_pk_mul_f32 v[10:11], v[70:71], v[22:23]
    v_pk_fma_f32 v[100:101], v[100:101], v[52:53], v[4:5]
    v_pk_fma_f32 v[116:117], v[116:117], v[52:53], v[6:7]
    v_pk_fma_f32 v[102:103], v[102:103], v[54:55], v[8:9]
    v_pk_fma_f32 v[118:119], v[118:119], v[54:55], v[10:11]
    v_pk_mul_f32 v[4:5], v[100:101], s[94:95]
    v_pk_mul_f32 v[8:9], v[102:103], s[94:95]
    v_exp_f32 v4, v4 clamp
    v_exp_f32 v5, v5 clamp
    v_exp_f32 v8, v8 clamp
    v_exp_f32 v9, v9 clamp
    v_cvt_pk_bf16_f32 v112, v116, v117
    buffer_load_dwordx4 v15, s[52:55], s76 offen offset:3072 lds
    s_add_u32 m0, s74, 16384
    s_add_u32 s76, s73, 114688
    buffer_load_dwordx4 v12, s[52:55], s76 offen offset:0 lds
    buffer_load_dwordx4 v13, s[52:55], s76 offen offset:1024 lds
    v_cvt_pk_bf16_f32 v113, v118, v119
    v_max_f32 v100, s93, v100
    v_max_f32 v101, s93, v101
    v_max_f32 v102, s93, v102
    v_max_f32 v103, s93, v103
    v_cndmask_b32 v112, v112, v36, s[96:97]
    v_cndmask_b32 v113, v113, v36, s[96:97]
    v_pk_add_f32 v[100:101], v[100:101], v[4:5]
    v_pk_add_f32 v[102:103], v[102:103], v[8:9]
    v_cvt_pk_bf16_f32 v96, v100, v101
    v_cvt_pk_bf16_f32 v97, v102, v103
    v_pk_fma_f32 v[4:5], v[72:73], v[20:21], s[98:99]
    v_pk_mul_f32 v[6:7], v[72:73], v[22:23]
    v_pk_fma_f32 v[8:9], v[74:75], v[20:21], s[98:99]
    v_pk_mul_f32 v[10:11], v[74:75], v[22:23]
    v_pk_fma_f32 v[104:105], v[104:105], v[56:57], v[4:5]
    v_pk_fma_f32 v[120:121], v[120:121], v[56:57], v[6:7]
    v_pk_fma_f32 v[106:107], v[106:107], v[58:59], v[8:9]
    v_pk_fma_f32 v[122:123], v[122:123], v[58:59], v[10:11]
    v_pk_mul_f32 v[4:5], v[104:105], s[94:95]
    v_pk_mul_f32 v[8:9], v[106:107], s[94:95]
    v_exp_f32 v4, v4 clamp
    v_exp_f32 v5, v5 clamp
    v_exp_f32 v8, v8 clamp
    v_exp_f32 v9, v9 clamp
    v_cvt_pk_bf16_f32 v114, v120, v121
    v_cvt_pk_bf16_f32 v115, v122, v123
    v_max_f32 v104, s93, v104
    v_max_f32 v105, s93, v105
    v_max_f32 v106, s93, v106
    v_max_f32 v107, s93, v107
    v_cndmask_b32 v114, v114, v36, s[96:97]
    v_cndmask_b32 v115, v115, v36, s[96:97]
    v_pk_add_f32 v[104:105], v[104:105], v[4:5]
    v_pk_add_f32 v[106:107], v[106:107], v[8:9]
    v_cvt_pk_bf16_f32 v98, v104, v105
    v_cvt_pk_bf16_f32 v99, v106, v107
    s_waitcnt lgkmcnt(0)
    s_nop 0
    v_pk_fma_f32 v[4:5], v[236:237], v[20:21], s[98:99]
    v_pk_mul_f32 v[6:7], v[236:237], v[22:23]
    v_pk_fma_f32 v[8:9], v[238:239], v[20:21], s[98:99]
    v_pk_mul_f32 v[10:11], v[238:239], v[22:23]
    v_pk_fma_f32 v[124:125], v[124:125], v[220:221], v[4:5]
    ds_read_b128 v[44:47], v37 offset:256
    ds_read_b128 v[60:63], v37 offset:768
    ds_read_b128 v[48:51], v37 offset:288
    ds_read_b128 v[64:67], v37 offset:800
    ds_read_b128 v[52:55], v37 offset:320
    ds_read_b128 v[68:71], v37 offset:832
    ds_read_b128 v[56:59], v37 offset:352
    ds_read_b128 v[72:75], v37 offset:864
    v_pk_fma_f32 v[140:141], v[140:141], v[220:221], v[6:7]
    v_pk_fma_f32 v[126:127], v[126:127], v[222:223], v[8:9]
    v_pk_fma_f32 v[142:143], v[142:143], v[222:223], v[10:11]
    v_pk_mul_f32 v[4:5], v[124:125], s[94:95]
    v_pk_mul_f32 v[8:9], v[126:127], s[94:95]
    v_exp_f32 v4, v4 clamp
    v_exp_f32 v5, v5 clamp
    v_exp_f32 v8, v8 clamp
    v_exp_f32 v9, v9 clamp
    v_cvt_pk_bf16_f32 v140, v140, v141
    v_cvt_pk_bf16_f32 v141, v142, v143
    v_max_f32 v124, s93, v124
    v_max_f32 v125, s93, v125
    v_max_f32 v126, s93, v126
    v_max_f32 v127, s93, v127
    v_cndmask_b32 v140, v140, v36, s[96:97]
    v_cndmask_b32 v141, v141, v36, s[96:97]
    v_pk_add_f32 v[124:125], v[124:125], v[4:5]
    v_pk_add_f32 v[126:127], v[126:127], v[8:9]
    v_cvt_pk_bf16_f32 v124, v124, v125
    v_cvt_pk_bf16_f32 v125, v126, v127
    v_pk_fma_f32 v[4:5], v[240:241], v[20:21], s[98:99]
    v_pk_mul_f32 v[6:7], v[240:241], v[22:23]
    v_pk_fma_f32 v[8:9], v[242:243], v[20:21], s[98:99]
    v_pk_mul_f32 v[10:11], v[242:243], v[22:23]
    v_pk_fma_f32 v[128:129], v[128:129], v[224:225], v[4:5]
    v_pk_fma_f32 v[144:145], v[144:145], v[224:225], v[6:7]
    v_pk_fma_f32 v[130:131], v[130:131], v[226:227], v[8:9]
    v_pk_fma_f32 v[146:147], v[146:147], v[226:227], v[10:11]
    v_pk_mul_f32 v[4:5], v[128:129], s[94:95]
    v_pk_mul_f32 v[8:9], v[130:131], s[94:95]
    buffer_load_dwordx4 v14, s[52:55], s76 offen offset:2048 lds
    buffer_load_dwordx4 v15, s[52:55], s76 offen offset:3072 lds
    s_add_u32 m0, s20, 0
    s_add_u32 s76, s73, 143360
    buffer_load_dwordx4 v12, s[52:55], s76 offen offset:0 lds
    v_exp_f32 v4, v4 clamp
    v_exp_f32 v5, v5 clamp
    v_exp_f32 v8, v8 clamp
    v_exp_f32 v9, v9 clamp
    v_cvt_pk_bf16_f32 v142, v144, v145
    v_cvt_pk_bf16_f32 v143, v146, v147
    v_max_f32 v128, s93, v128
    v_max_f32 v129, s93, v129
    v_max_f32 v130, s93, v130
    v_max_f32_e64 v131, s93, v131
    v_cndmask_b32 v142, v142, v36, s[96:97]
    v_cndmask_b32 v143, v143, v36, s[96:97]
    v_pk_add_f32 v[128:129], v[128:129], v[4:5]
    v_pk_add_f32 v[130:131], v[130:131], v[8:9]
    v_cvt_pk_bf16_f32 v126, v128, v129
    v_cvt_pk_bf16_f32 v127, v130, v131
    v_pk_fma_f32 v[4:5], v[244:245], v[20:21], s[98:99]
    v_pk_mul_f32 v[6:7], v[244:245], v[22:23]
    v_pk_fma_f32 v[8:9], v[246:247], v[20:21], s[98:99]
    v_pk_mul_f32 v[10:11], v[246:247], v[22:23]
    v_pk_fma_f32 v[132:133], v[132:133], v[228:229], v[4:5]
    v_pk_fma_f32 v[148:149], v[148:149], v[228:229], v[6:7]
    v_pk_fma_f32 v[134:135], v[134:135], v[230:231], v[8:9]
    v_pk_fma_f32 v[150:151], v[150:151], v[230:231], v[10:11]
    v_pk_mul_f32 v[4:5], v[132:133], s[94:95]
    v_pk_mul_f32 v[8:9], v[134:135], s[94:95]
    v_exp_f32 v4, v4 clamp
    v_exp_f32 v5, v5 clamp
    v_exp_f32 v8, v8 clamp
    v_exp_f32 v9, v9 clamp
    v_cvt_pk_bf16_f32 v144, v148, v149
    buffer_load_dwordx4 v13, s[52:55], s76 offen offset:1024 lds
    buffer_load_dwordx4 v14, s[52:55], s76 offen offset:2048 lds
    buffer_load_dwordx4 v15, s[52:55], s76 offen offset:3072 lds
    v_cvt_pk_bf16_f32 v145, v150, v151
    v_max_f32 v132, s93, v132
    v_max_f32 v133, s93, v133
    v_max_f32 v134, s93, v134
    v_max_f32 v135, s93, v135
    v_cndmask_b32 v144, v144, v36, s[96:97]
    v_cndmask_b32 v145, v145, v36, s[96:97]
    v_pk_add_f32 v[132:133], v[132:133], v[4:5]
    v_pk_add_f32 v[134:135], v[134:135], v[8:9]
    v_cvt_pk_bf16_f32 v128, v132, v133
    v_cvt_pk_bf16_f32 v129, v134, v135
    v_pk_fma_f32 v[4:5], v[248:249], v[20:21], s[98:99]
    v_pk_mul_f32 v[6:7], v[248:249], v[22:23]
    v_pk_fma_f32 v[8:9], v[250:251], v[20:21], s[98:99]
    v_pk_mul_f32 v[10:11], v[250:251], v[22:23]
    v_pk_fma_f32 v[136:137], v[136:137], v[232:233], v[4:5]
    v_pk_fma_f32 v[152:153], v[152:153], v[232:233], v[6:7]
    v_pk_fma_f32 v[138:139], v[138:139], v[234:235], v[8:9]
    v_pk_fma_f32 v[154:155], v[154:155], v[234:235], v[10:11]
    v_pk_mul_f32 v[4:5], v[136:137], s[94:95]
    v_pk_mul_f32 v[8:9], v[138:139], s[94:95]
    v_exp_f32 v4, v4 clamp
    v_exp_f32 v5, v5 clamp
    v_exp_f32 v8, v8 clamp
    v_exp_f32 v9, v9 clamp
    v_cvt_pk_bf16_f32 v146, v152, v153
    v_cvt_pk_bf16_f32 v147, v154, v155
    v_max_f32 v136, s93, v136
    v_max_f32 v137, s93, v137
    v_max_f32 v138, s93, v138
    v_max_f32 v139, s93, v139
    v_cndmask_b32 v146, v146, v36, s[96:97]
    v_cndmask_b32 v147, v147, v36, s[96:97]
    v_pk_add_f32 v[136:137], v[136:137], v[4:5]
    v_pk_add_f32 v[138:139], v[138:139], v[8:9]
    v_cvt_pk_bf16_f32 v130, v136, v137
    v_cvt_pk_bf16_f32 v131, v138, v139
    s_waitcnt lgkmcnt(0)
    s_nop 0
    v_pk_fma_f32 v[4:5], v[60:61], v[20:21], s[98:99]
    v_pk_mul_f32 v[6:7], v[60:61], v[22:23]
    v_pk_fma_f32 v[8:9], v[62:63], v[20:21], s[98:99]
    v_pk_mul_f32 v[10:11], v[62:63], v[22:23]
    v_pk_fma_f32 v[156:157], v[156:157], v[44:45], v[4:5]
    ds_read_b128 v[220:223], v37 offset:384
    ds_read_b128 v[236:239], v37 offset:896
    ds_read_b128 v[224:227], v37 offset:416
    ds_read_b128 v[240:243], v37 offset:928
    ds_read_b128 v[228:231], v37 offset:448
    ds_read_b128 v[244:247], v37 offset:960
    ds_read_b128 v[232:235], v37 offset:480
    ds_read_b128 v[248:251], v37 offset:992
    v_pk_fma_f32 v[172:173], v[172:173], v[44:45], v[6:7]
    v_pk_fma_f32 v[158:159], v[158:159], v[46:47], v[8:9]
    v_pk_fma_f32 v[174:175], v[174:175], v[46:47], v[10:11]
    v_pk_mul_f32 v[4:5], v[156:157], s[94:95]
    v_pk_mul_f32 v[8:9], v[158:159], s[94:95]
    v_exp_f32 v4, v4 clamp
    v_exp_f32 v5, v5 clamp
    v_exp_f32 v8, v8 clamp
    v_exp_f32 v9, v9 clamp
    v_cvt_pk_bf16_f32 v172, v172, v173
    v_cvt_pk_bf16_f32 v173, v174, v175
    v_max_f32 v156, s93, v156
    v_max_f32 v157, s93, v157
    v_max_f32 v158, s93, v158
    v_max_f32 v159, s93, v159
    v_cndmask_b32 v172, v172, v36, s[96:97]
    v_cndmask_b32 v173, v173, v36, s[96:97]
    v_pk_add_f32 v[156:157], v[156:157], v[4:5]
    v_pk_add_f32 v[158:159], v[158:159], v[8:9]
    v_cvt_pk_bf16_f32 v156, v156, v157
    v_cvt_pk_bf16_f32 v157, v158, v159
    v_pk_fma_f32 v[4:5], v[64:65], v[20:21], s[98:99]
    v_pk_mul_f32 v[6:7], v[64:65], v[22:23]
    v_pk_fma_f32 v[8:9], v[66:67], v[20:21], s[98:99]
    v_pk_mul_f32 v[10:11], v[66:67], v[22:23]
    v_pk_fma_f32 v[160:161], v[160:161], v[48:49], v[4:5]
    v_pk_fma_f32 v[176:177], v[176:177], v[48:49], v[6:7]
    v_pk_fma_f32 v[162:163], v[162:163], v[50:51], v[8:9]
    v_pk_fma_f32 v[178:179], v[178:179], v[50:51], v[10:11]
    v_pk_mul_f32 v[4:5], v[160:161], s[94:95]
    v_pk_mul_f32 v[8:9], v[162:163], s[94:95]
    s_add_u32 m0, s20, 4096
    s_add_u32 s76, s73, 172032
    buffer_load_dwordx4 v12, s[52:55], s76 offen offset:0 lds
    buffer_load_dwordx4 v13, s[52:55], s76 offen offset:1024 lds
    buffer_load_dwordx4 v14, s[52:55], s76 offen offset:2048 lds
    v_exp_f32 v4, v4 clamp
    v_exp_f32 v5, v5 clamp
    v_exp_f32 v8, v8 clamp
    v_exp_f32 v9, v9 clamp
    v_cvt_pk_bf16_f32 v174, v176, v177
    v_cvt_pk_bf16_f32 v175, v178, v179
    v_max_f32 v160, s93, v160
    v_max_f32 v161, s93, v161
    v_max_f32 v162, s93, v162
    v_max_f32 v163, s93, v163
    v_cndmask_b32 v174, v174, v36, s[96:97]
    v_cndmask_b32 v175, v175, v36, s[96:97]
    v_pk_add_f32 v[160:161], v[160:161], v[4:5]
    v_pk_add_f32 v[162:163], v[162:163], v[8:9]
    v_cvt_pk_bf16_f32 v158, v160, v161
    v_cvt_pk_bf16_f32 v159, v162, v163
    v_pk_fma_f32 v[4:5], v[68:69], v[20:21], s[98:99]
    v_pk_mul_f32 v[6:7], v[68:69], v[22:23]
    v_pk_fma_f32 v[8:9], v[70:71], v[20:21], s[98:99]
    v_pk_mul_f32 v[10:11], v[70:71], v[22:23]
    v_pk_fma_f32 v[164:165], v[164:165], v[52:53], v[4:5]
    v_pk_fma_f32 v[180:181], v[180:181], v[52:53], v[6:7]
    v_pk_fma_f32 v[166:167], v[166:167], v[54:55], v[8:9]
    v_pk_fma_f32 v[182:183], v[182:183], v[54:55], v[10:11]
    v_pk_mul_f32 v[4:5], v[164:165], s[94:95]
    v_pk_mul_f32 v[8:9], v[166:167], s[94:95]
    v_exp_f32 v4, v4 clamp
    v_exp_f32 v5, v5 clamp
    v_exp_f32 v8, v8 clamp
    v_exp_f32 v9, v9 clamp
    v_cvt_pk_bf16_f32 v176, v180, v181
    buffer_load_dwordx4 v15, s[52:55], s76 offen offset:3072 lds
    s_add_u32 m0, s20, 8192
    s_add_u32 s76, s73, 200704
    buffer_load_dwordx4 v12, s[52:55], s76 offen offset:0 lds
    buffer_load_dwordx4 v13, s[52:55], s76 offen offset:1024 lds
    v_cvt_pk_bf16_f32 v177, v182, v183
    v_max_f32 v164, s93, v164
    v_max_f32 v165, s93, v165
    v_max_f32 v166, s93, v166
    v_max_f32 v167, s93, v167
    v_cndmask_b32 v176, v176, v36, s[96:97]
    v_cndmask_b32 v177, v177, v36, s[96:97]
    v_pk_add_f32 v[164:165], v[164:165], v[4:5]
    v_pk_add_f32 v[166:167], v[166:167], v[8:9]
    v_cvt_pk_bf16_f32 v160, v164, v165
    v_cvt_pk_bf16_f32 v161, v166, v167
    v_pk_fma_f32 v[4:5], v[72:73], v[20:21], s[98:99]
    v_pk_mul_f32 v[6:7], v[72:73], v[22:23]
    v_pk_fma_f32 v[8:9], v[74:75], v[20:21], s[98:99]
    v_pk_mul_f32 v[10:11], v[74:75], v[22:23]
    v_pk_fma_f32 v[168:169], v[168:169], v[56:57], v[4:5]
    v_pk_fma_f32 v[184:185], v[184:185], v[56:57], v[6:7]
    v_pk_fma_f32 v[170:171], v[170:171], v[58:59], v[8:9]
    v_pk_fma_f32 v[186:187], v[186:187], v[58:59], v[10:11]
    v_pk_mul_f32 v[4:5], v[168:169], s[94:95]
    v_pk_mul_f32 v[8:9], v[170:171], s[94:95]
    v_exp_f32 v4, v4 clamp
    v_exp_f32 v5, v5 clamp
    v_exp_f32 v8, v8 clamp
    v_exp_f32 v9, v9 clamp
    v_cvt_pk_bf16_f32 v178, v184, v185
    v_cvt_pk_bf16_f32 v179, v186, v187
    v_max_f32 v168, s93, v168
    v_max_f32 v169, s93, v169
    v_max_f32 v170, s93, v170
    v_max_f32 v171, s93, v171
    v_cndmask_b32 v178, v178, v36, s[96:97]
    v_cndmask_b32 v179, v179, v36, s[96:97]
    v_pk_add_f32 v[168:169], v[168:169], v[4:5]
    v_pk_add_f32 v[170:171], v[170:171], v[8:9]
    v_cvt_pk_bf16_f32 v162, v168, v169
    v_cvt_pk_bf16_f32 v163, v170, v171
    s_waitcnt lgkmcnt(0)
    s_nop 0
    v_pk_fma_f32 v[4:5], v[236:237], v[20:21], s[98:99]
    v_pk_mul_f32 v[6:7], v[236:237], v[22:23]
    v_pk_fma_f32 v[8:9], v[238:239], v[20:21], s[98:99]
    v_pk_mul_f32 v[10:11], v[238:239], v[22:23]
    v_pk_fma_f32 v[188:189], v[188:189], v[220:221], v[4:5]
    buffer_load_dwordx4 v14, s[52:55], s76 offen offset:2048 lds
    buffer_load_dwordx4 v15, s[52:55], s76 offen offset:3072 lds
    s_add_u32 m0, s20, 12288
    s_add_u32 s76, s73, 229376
    buffer_load_dwordx4 v12, s[52:55], s76 offen offset:0 lds
    v_pk_fma_f32 v[204:205], v[204:205], v[220:221], v[6:7]
    v_pk_fma_f32 v[190:191], v[190:191], v[222:223], v[8:9]
    v_pk_fma_f32 v[206:207], v[206:207], v[222:223], v[10:11]
    v_pk_mul_f32 v[4:5], v[188:189], s[94:95]
    v_pk_mul_f32 v[8:9], v[190:191], s[94:95]
    v_exp_f32 v4, v4 clamp
    v_exp_f32 v5, v5 clamp
    v_exp_f32 v8, v8 clamp
    v_exp_f32 v9, v9 clamp
    v_cvt_pk_bf16_f32 v204, v204, v205
    v_cvt_pk_bf16_f32 v205, v206, v207
    v_max_f32 v188, s93, v188
    v_max_f32 v189, s93, v189
    v_max_f32 v190, s93, v190
    v_max_f32 v191, s93, v191
    v_cndmask_b32 v204, v204, v36, s[96:97]
    v_cndmask_b32 v205, v205, v36, s[96:97]
    v_pk_add_f32 v[188:189], v[188:189], v[4:5]
    v_pk_add_f32 v[190:191], v[190:191], v[8:9]
    v_cvt_pk_bf16_f32 v188, v188, v189
    v_cvt_pk_bf16_f32 v189, v190, v191
    v_pk_fma_f32 v[4:5], v[240:241], v[20:21], s[98:99]
    v_pk_mul_f32 v[6:7], v[240:241], v[22:23]
    v_pk_fma_f32 v[8:9], v[242:243], v[20:21], s[98:99]
    v_pk_mul_f32 v[10:11], v[242:243], v[22:23]
    v_pk_fma_f32 v[192:193], v[192:193], v[224:225], v[4:5]
    v_pk_fma_f32 v[208:209], v[208:209], v[224:225], v[6:7]
    v_pk_fma_f32 v[194:195], v[194:195], v[226:227], v[8:9]
    v_pk_fma_f32 v[210:211], v[210:211], v[226:227], v[10:11]
    v_pk_mul_f32 v[4:5], v[192:193], s[94:95]
    v_pk_mul_f32 v[8:9], v[194:195], s[94:95]
    v_exp_f32 v4, v4 clamp
    v_exp_f32 v5, v5 clamp
    v_exp_f32 v8, v8 clamp
    v_exp_f32 v9, v9 clamp
    v_cvt_pk_bf16_f32 v206, v208, v209
    v_cvt_pk_bf16_f32 v207, v210, v211
    v_max_f32 v192, s93, v192
    v_max_f32 v193, s93, v193
    v_max_f32 v194, s93, v194
    v_max_f32 v195, s93, v195
    v_cndmask_b32 v206, v206, v36, s[96:97]
    v_cndmask_b32 v207, v207, v36, s[96:97]
    v_pk_add_f32 v[192:193], v[192:193], v[4:5]
    v_pk_add_f32 v[194:195], v[194:195], v[8:9]
    v_cvt_pk_bf16_f32 v190, v192, v193
    buffer_load_dwordx4 v13, s[52:55], s76 offen offset:1024 lds
    buffer_load_dwordx4 v14, s[52:55], s76 offen offset:2048 lds
    buffer_load_dwordx4 v15, s[52:55], s76 offen offset:3072 lds
    v_cvt_pk_bf16_f32 v191, v194, v195
    v_pk_fma_f32 v[4:5], v[244:245], v[20:21], s[98:99]
    v_pk_mul_f32 v[6:7], v[244:245], v[22:23]
    v_pk_fma_f32 v[8:9], v[246:247], v[20:21], s[98:99]
    v_pk_mul_f32 v[10:11], v[246:247], v[22:23]
    v_pk_fma_f32 v[196:197], v[196:197], v[228:229], v[4:5]
    v_pk_fma_f32 v[212:213], v[212:213], v[228:229], v[6:7]
    v_pk_fma_f32 v[198:199], v[198:199], v[230:231], v[8:9]
    v_pk_fma_f32 v[214:215], v[214:215], v[230:231], v[10:11]
    v_pk_mul_f32 v[4:5], v[196:197], s[94:95]
    v_pk_mul_f32 v[8:9], v[198:199], s[94:95]
    v_exp_f32 v4, v4 clamp
    v_exp_f32 v5, v5 clamp
    v_exp_f32 v8, v8 clamp
    v_exp_f32 v9, v9 clamp
    v_cvt_pk_bf16_f32 v208, v212, v213
    v_cvt_pk_bf16_f32 v209, v214, v215
    v_max_f32 v196, s93, v196
    v_max_f32 v197, s93, v197
    v_max_f32 v198, s93, v198
    v_max_f32 v199, s93, v199
    v_cndmask_b32 v208, v208, v36, s[96:97]
    v_cndmask_b32 v209, v209, v36, s[96:97]
    v_pk_add_f32 v[196:197], v[196:197], v[4:5]
    v_pk_add_f32 v[198:199], v[198:199], v[8:9]
    v_cvt_pk_bf16_f32 v192, v196, v197
    v_cvt_pk_bf16_f32 v193, v198, v199
    v_pk_fma_f32 v[4:5], v[248:249], v[20:21], s[98:99]
    v_pk_mul_f32 v[6:7], v[248:249], v[22:23]
    v_pk_fma_f32 v[8:9], v[250:251], v[20:21], s[98:99]
    v_pk_mul_f32 v[10:11], v[250:251], v[22:23]
    v_pk_fma_f32 v[200:201], v[200:201], v[232:233], v[4:5]
    v_pk_fma_f32 v[216:217], v[216:217], v[232:233], v[6:7]
    v_pk_fma_f32 v[202:203], v[202:203], v[234:235], v[8:9]
    v_pk_fma_f32 v[218:219], v[218:219], v[234:235], v[10:11]
    v_pk_mul_f32 v[4:5], v[200:201], s[94:95]
    v_pk_mul_f32 v[8:9], v[202:203], s[94:95]
    v_exp_f32 v4, v4 clamp
    v_exp_f32 v5, v5 clamp
    v_exp_f32 v8, v8 clamp
    v_exp_f32 v9, v9 clamp
    v_cvt_pk_bf16_f32 v210, v216, v217
    v_cvt_pk_bf16_f32 v211, v218, v219
    v_max_f32 v200, s93, v200
    v_max_f32 v201, s93, v201
    v_max_f32 v202, s93, v202
    v_max_f32 v203, s93, v203
    v_cndmask_b32 v210, v210, v36, s[96:97]
    v_cndmask_b32 v211, v211, v36, s[96:97]
    v_pk_add_f32 v[200:201], v[200:201], v[4:5]
    v_pk_add_f32 v[202:203], v[202:203], v[8:9]
    v_cvt_pk_bf16_f32 v194, v200, v201
    v_cvt_pk_bf16_f32 v195, v202, v203
    v_mfma_f32_32x32x16_bf16 v[76:91], v[92:95], v[108:111], 0
    v_mfma_f32_32x32x16_bf16 v[76:91], v[96:99], v[112:115], v[76:91]
    v_mfma_f32_32x32x16_bf16 v[76:91], v[124:127], v[140:143], v[76:91]
    v_mfma_f32_32x32x16_bf16 v[76:91], v[128:131], v[144:147], v[76:91]
    v_mfma_f32_32x32x16_bf16 v[76:91], v[156:159], v[172:175], v[76:91]
    v_mfma_f32_32x32x16_bf16 v[76:91], v[160:163], v[176:179], v[76:91]
    v_mfma_f32_32x32x16_bf16 v[76:91], v[188:191], v[204:207], v[76:91]
    v_mfma_f32_32x32x16_bf16 v[76:91], v[192:195], v[208:211], v[76:91]
    s_nop 11
    s_nop 0
    buffer_atomic_add_f32 v76, v38, s[44:47], s86 offen offset:0
    buffer_atomic_add_f32 v77, v38, s[44:47], s86 offen offset:128
    buffer_atomic_add_f32 v78, v38, s[44:47], s86 offen offset:256
    buffer_atomic_add_f32 v79, v38, s[44:47], s86 offen offset:384
    buffer_atomic_add_f32 v80, v38, s[44:47], s86 offen offset:1024
    buffer_atomic_add_f32 v81, v38, s[44:47], s86 offen offset:1152
    buffer_atomic_add_f32 v82, v38, s[44:47], s86 offen offset:1280
    buffer_atomic_add_f32 v83, v38, s[44:47], s86 offen offset:1408
    buffer_atomic_add_f32 v84, v38, s[44:47], s86 offen offset:2048
    buffer_atomic_add_f32 v85, v38, s[44:47], s86 offen offset:2176
    buffer_atomic_add_f32 v86, v38, s[44:47], s86 offen offset:2304
    buffer_atomic_add_f32 v87, v38, s[44:47], s86 offen offset:2432
    buffer_atomic_add_f32 v88, v39, s[44:47], s86 offen offset:3072
    buffer_atomic_add_f32 v89, v39, s[44:47], s86 offen offset:3200
    buffer_atomic_add_f32 v90, v39, s[44:47], s86 offen offset:3328
    buffer_atomic_add_f32 v91, v39, s[44:47], s86 offen offset:3456
    s_lshl_b32 s86, s71, 8
    s_lshl_b32 s89, s68, 2
    s_add_u32 s86, s86, s89
    s_add_u32 s86, s86, 9577472
    s_waitcnt vmcnt(16)
L_pub:
    s_cmp_eq_u32 s64, 2
    s_cbranch_scc1 L_t1
    ds_read_b64_tr_b16 a[0:1], v252 offset:0
    ds_read_b64_tr_b16 a[2:3], v252 offset:1024
    ds_read_b64_tr_b16 a[4:5], v253 offset:0
    ds_read_b64_tr_b16 a[6:7], v253 offset:1024
    ds_read_b64_tr_b16 a[8:9], v252 offset:2048
    ds_read_b64_tr_b16 a[10:11], v252 offset:3072
    ds_read_b64_tr_b16 a[12:13], v253 offset:2048
    ds_read_b64_tr_b16 a[14:15], v253 offset:3072
    ds_read_b64_tr_b16 a[16:17], v252 offset:4096
    ds_read_b64_tr_b16 a[18:19], v252 offset:5120
    ds_read_b64_tr_b16 a[20:21], v253 offset:4096
    ds_read_b64_tr_b16 a[22:23], v253 offset:5120
    ds_read_b64_tr_b16 a[24:25], v252 offset:6144
    ds_read_b64_tr_b16 a[26:27], v252 offset:7168
    ds_read_b64_tr_b16 a[28:29], v253 offset:6144
    ds_read_b64_tr_b16 a[30:31], v253 offset:7168
    ds_read_b64_tr_b16 a[32:33], v252 offset:8192
    ds_read_b64_tr_b16 a[34:35], v252 offset:9216
    ds_read_b64_tr_b16 a[36:37], v253 offset:8192
    ds_read_b64_tr_b16 a[38:39], v253 offset:9216
    ds_read_b64_tr_b16 a[40:41], v252 offset:10240
    ds_read_b64_tr_b16 a[42:43], v252 offset:11264
    ds_read_b64_tr_b16 a[44:45], v253 offset:10240
    ds_read_b64_tr_b16 a[46:47], v253 offset:11264
    ds_read_b64_tr_b16 a[48:49], v252 offset:12288
    ds_read_b64_tr_b16 a[50:51], v252 offset:13312
    ds_read_b64_tr_b16 a[52:53], v253 offset:12288
    ds_read_b64_tr_b16 a[54:55], v253 offset:13312
    ds_read_b64_tr_b16 a[56:57], v252 offset:14336
    ds_read_b64_tr_b16 a[58:59], v252 offset:15360
    ds_read_b64_tr_b16 a[60:61], v253 offset:14336
    ds_read_b64_tr_b16 a[62:63], v253 offset:15360
    ds_read_b64_tr_b16 a[64:65], v252 offset:16384
    ds_read_b64_tr_b16 a[66:67], v252 offset:17408
    ds_read_b64_tr_b16 a[68:69], v253 offset:16384
    ds_read_b64_tr_b16 a[70:71], v253 offset:17408
    ds_read_b64_tr_b16 a[72:73], v252 offset:18432
    ds_read_b64_tr_b16 a[74:75], v252 offset:19456
    ds_read_b64_tr_b16 a[76:77], v253 offset:18432
    ds_read_b64_tr_b16 a[78:79], v253 offset:19456
    ds_read_b64_tr_b16 a[80:81], v16 offset:0
    ds_read_b64_tr_b16 a[82:83], v16 offset:1024
    ds_read_b64_tr_b16 a[84:85], v17 offset:0
    ds_read_b64_tr_b16 a[86:87], v17 offset:1024
    ds_read_b64_tr_b16 a[88:89], v16 offset:2048
    ds_read_b64_tr_b16 a[90:91], v16 offset:3072
    ds_read_b64_tr_b16 a[92:93], v17 offset:2048
    ds_read_b64_tr_b16 a[94:95], v17 offset:3072
    ds_read_b64_tr_b16 a[96:97], v16 offset:4096
    ds_read_b64_tr_b16 a[98:99], v16 offset:5120
    ds_read_b64_tr_b16 a[100:101], v17 offset:4096
    ds_read_b64_tr_b16 a[102:103], v17 offset:5120
    ds_read_b64_tr_b16 a[104:105], v16 offset:6144
    ds_read_b64_tr_b16 a[106:107], v16 offset:7168
    ds_read_b64_tr_b16 a[108:109], v17 offset:6144
    ds_read_b64_tr_b16 a[110:111], v17 offset:7168
    ds_read_b64_tr_b16 a[112:113], v16 offset:8192
    ds_read_b64_tr_b16 a[114:115], v16 offset:9216
    ds_read_b64_tr_b16 a[116:117], v17 offset:8192
    ds_read_b64_tr_b16 a[118:119], v17 offset:9216
    ds_read_b64_tr_b16 a[120:121], v16 offset:10240
    ds_read_b64_tr_b16 a[122:123], v16 offset:11264
    ds_read_b64_tr_b16 a[124:125], v17 offset:10240
    ds_read_b64_tr_b16 a[126:127], v17 offset:11264
    ds_read_b64_tr_b16 a[128:129], v16 offset:12288
    ds_read_b64_tr_b16 a[130:131], v16 offset:13312
    ds_read_b64_tr_b16 a[132:133], v17 offset:12288
    ds_read_b64_tr_b16 a[134:135], v17 offset:13312
    ds_read_b64_tr_b16 a[136:137], v16 offset:14336
    ds_read_b64_tr_b16 a[138:139], v16 offset:15360
    ds_read_b64_tr_b16 a[140:141], v17 offset:14336
    ds_read_b64_tr_b16 a[142:143], v17 offset:15360
    v_mov_b32 v8, v252
    v_mov_b32 v9, v253
    v_mov_b32 v122, v16
    v_mov_b32 v123, v17
    v_lshlrev_b32 v124, 4, v1
    s_waitcnt lgkmcnt(15)
    s_add_u32 m0, s74, 14336
    s_add_u32 s76, s73, 258048
    buffer_load_dwordx4 v12, s[52:55], s76 offen offset:0 lds
    buffer_load_dwordx4 v13, s[52:55], s76 offen offset:1024 lds
    buffer_load_dwordx4 v14, s[52:55], s76 offen offset:2048 lds
    buffer_load_dwordx4 v15, s[52:55], s76 offen offset:3072 lds
    s_add_u32 m0, s74, 18432
    s_add_u32 s76, s73, 286720
    buffer_load_dwordx4 v12, s[52:55], s76 offen offset:0 lds
    buffer_load_dwordx4 v13, s[52:55], s76 offen offset:1024 lds
    s_add_u32 m0, s74, 0
    s_add_u32 s76, s75, 0
    buffer_load_dwordx4 v12, s[56:59], s76 offen offset:0 lds
    buffer_load_dwordx4 v13, s[56:59], s76 offen offset:1024 lds
    buffer_load_dwordx4 v14, s[56:59], s76 offen offset:2048 lds
    buffer_load_dwordx4 v15, s[56:59], s76 offen offset:3072 lds
    s_waitcnt lgkmcnt(0)
    s_add_u32 m0, s20, 0
    s_add_u32 s76, s73, 301056
    buffer_load_dwordx4 v12, s[52:55], s76 offen offset:0 lds
    buffer_load_dwordx4 v13, s[52:55], s76 offen offset:1024 lds
    buffer_load_dwordx4 v14, s[52:55], s76 offen offset:2048 lds
    buffer_load_dwordx4 v15, s[52:55], s76 offen offset:3072 lds
    s_add_u32 m0, s20, 4096
    s_add_u32 s76, s73, 329728
    buffer_load_dwordx4 v12, s[52:55], s76 offen offset:0 lds
    buffer_load_dwordx4 v13, s[52:55], s76 offen offset:1024 lds
    buffer_load_dword v120, v3, s[44:47], s43 offen sc1
    s_waitcnt vmcnt(17)
    s_barrier
    s_cmp_lg_u32 s70, 0
    s_cbranch_scc1 PB_19
    v_mov_b32 v18, s3
    s_mov_b64 exec, 1
    buffer_store_dword v18, off, s[44:47], s86 sc1
    s_mov_b64 exec, -1
PB_19:
    s_cmp_eq_u32 s79, 0
    s_cbranch_scc1 L_end
    s_waitcnt vmcnt(0)
    v_cmp_eq_u32 vcc, s3, v120
    s_nop 0
    s_cmp_eq_u64 vcc, -1
    s_cbranch_scc1 FK_20
    s_mov_b32 s92, 30000
SP_21:
    buffer_load_dword v120, v3, s[44:47], s43 offen sc1
    s_waitcnt vmcnt(0)
    v_cmp_eq_u32 vcc, s3, v120
    s_nop 0
    s_cmp_eq_u64 vcc, -1
    s_cbranch_scc1 SD_22
    s_sub_u32 s92, s92, 1
    s_cmp_eq_u32 s92, 0
    s_cbranch_scc0 SP_21
SD_22:
FK_20:
    buffer_load_dwordx4 v[80:83], v124, s[44:47], s32 offen offset:0 sc1
    buffer_load_dwordx4 v[84:87], v124, s[44:47], s39 offen offset:0 sc1
    buffer_load_dwordx4 v[88:91], v124, s[44:47], s32 offen offset:1024 sc1
    buffer_load_dwordx4 v[92:95], v124, s[44:47], s39 offen offset:1024 sc1
    buffer_load_dwordx4 v[96:99], v124, s[44:47], s32 offen offset:2048 sc1
    buffer_load_dwordx4 v[100:103], v124, s[44:47], s39 offen offset:2048 sc1
    buffer_load_dwordx4 v[104:107], v124, s[44:47], s32 offen offset:3072 sc1
    buffer_load_dwordx4 v[108:111], v124, s[44:47], s39 offen offset:3072 sc1
    buffer_load_dwordx4 v[112:115], v124, s[44:47], s33 offen offset:0 sc1
    buffer_load_dwordx4 v[116:119], v124, s[44:47], s21 offen offset:0 sc1
    buffer_load_dwordx4 v[240:243], v124, s[44:47], s33 offen offset:1024 sc1
    buffer_load_dwordx4 v[244:247], v124, s[44:47], s21 offen offset:1024 sc1
    buffer_load_dwordx4 a[224:227], v124, s[44:47], s33 offen offset:2048 sc1
    buffer_load_dwordx4 a[228:231], v124, s[44:47], s21 offen offset:2048 sc1
    buffer_load_dwordx4 a[232:235], v124, s[44:47], s33 offen offset:3072 sc1
    buffer_load_dwordx4 a[236:239], v124, s[44:47], s21 offen offset:3072 sc1
    buffer_load_dwordx4 a[240:243], v124, s[44:47], s34 offen offset:0 sc1
    buffer_load_dwordx4 a[244:247], v124, s[44:47], s24 offen offset:0 sc1
    buffer_load_dwordx4 a[248:251], v124, s[44:47], s34 offen offset:1024 sc1
    buffer_load_dwordx4 a[252:255], v124, s[44:47], s24 offen offset:1024 sc1
    buffer_load_dwordx4 v[176:179], v124, s[44:47], s34 offen offset:2048 sc1
    buffer_load_dwordx4 v[180:183], v124, s[44:47], s24 offen offset:2048 sc1
    buffer_load_dwordx4 v[184:187], v124, s[44:47], s34 offen offset:3072 sc1
    buffer_load_dwordx4 v[188:191], v124, s[44:47], s24 offen offset:3072 sc1
    buffer_load_dwordx4 v[192:195], v124, s[44:47], s35 offen offset:0 sc1
    buffer_load_dwordx4 v[196:199], v124, s[44:47], s25 offen offset:0 sc1
    s_getpc_b64 s[10:11]
L_c3:
    s_mul_i32 s12, s70, 2560
    v_min_u32 v4, 19, v1
    v_lshl_add_u32 v4, v4, 7, s12
    v_min_u32 v4, L_end-L_c3-4, v4
    global_load_dword v4, v4, s[10:11]
    ds_read_b64_tr_b16 a[144:145], v8 offset:14336
    ds_read_b64_tr_b16 a[146:147], v8 offset:15360
    ds_read_b64_tr_b16 a[148:149], v9 offset:14336
    ds_read_b64_tr_b16 a[150:151], v9 offset:15360
    ds_read_b64_tr_b16 a[152:153], v8 offset:16384
    ds_read_b64_tr_b16 a[154:155], v8 offset:17408
    ds_read_b64_tr_b16 a[156:157], v9 offset:16384
    ds_read_b64_tr_b16 a[158:159], v9 offset:17408
    ds_read_b64_tr_b16 a[160:161], v8 offset:18432
    ds_read_b64_tr_b16 a[162:163], v8 offset:19456
    ds_read_b64_tr_b16 a[164:165], v9 offset:18432
    ds_read_b64_tr_b16 a[166:167], v9 offset:19456
    s_mov_b32 s94, 0
    s_mov_b32 s95, -1
    s_waitcnt vmcnt(25)
    v_mfma_f32_32x32x16_bf16 v[16:31], a[0:3], v[80:83], 0
    buffer_load_dwordx4 v14, s[52:55], s76 offen offset:2048 lds
    s_add_u32 s41, s50, 4096
    s_add_u32 s99, s50, 8192
    s_add_u32 s4, s50, 12288
    s_add_u32 s5, s48, 4096
    v_mfma_f32_32x32x16_bf16 v[32:47], a[0:3], v[84:87], 0
    s_add_u32 s81, s49, 4096
    s_lshl_b32 s65, s70, 8
    s_add_u32 s65, s65, 9577472
    v_mfma_f32_32x32x16_bf16 v[48:63], a[4:7], v[80:83], 0
    buffer_load_dwordx4 v15, s[52:55], s76 offen offset:3072 lds
    v_lshrrev_b32 v128, 5, v1
    v_bfe_u32 v129, v1, 2, 2
    v_lshl_add_u32 v130, v128, 2, v129
    v_bfe_u32 v131, v1, 4, 1
    v_mfma_f32_32x32x16_bf16 v[64:79], a[4:7], v[84:87], 0
    v_lshlrev_b32 v131, 5, v131
    v_and_b32 v132, 3, v1
    v_lshl_add_u32 v131, v132, 3, v131
    s_waitcnt vmcnt(25)
    v_mfma_f32_32x32x16_bf16 v[16:31], a[8:11], v[88:91], v[16:31]
    s_add_u32 m0, s20, 8192
    s_add_u32 s76, s73, 358400
    buffer_load_dwordx4 v12, s[52:55], s76 offen offset:0 lds
    v_lshl_add_u32 v132, v130, 6, v131
    v_add_u32 v125, s20, v132
    v_lshl_add_u32 v130, v128, 1, v129
    v_bfe_u32 v132, v130, 1, 1
    v_mfma_f32_32x32x16_bf16 v[32:47], a[8:11], v[92:95], v[32:47]
    v_lshlrev_b32 v132, 6, v132
    v_xor_b32 v132, v131, v132
    v_lshl_add_u32 v132, v130, 7, v132
    v_mfma_f32_32x32x16_bf16 v[48:63], a[12:15], v[88:91], v[48:63]
    buffer_load_dwordx4 v13, s[52:55], s76 offen offset:1024 lds
    v_add_u32 v10, s74, v132
    v_xor_b32 v11, 64, v10
    v_lshrrev_b32 v130, 3, v1
    v_and_b32 v131, 7, v1
    v_mfma_f32_32x32x16_bf16 v[64:79], a[12:15], v[92:95], v[64:79]
    v_lshlrev_b32 v131, 3, v131
    v_lshl_add_u32 v131, v130, 6, v131
    v_add_u32 v127, s20, v131
    s_waitcnt vmcnt(25)
    v_mfma_f32_32x32x16_bf16 v[16:31], a[16:19], v[96:99], v[16:31]
    buffer_load_dword v121, v3, s[44:47], s51 offen sc1
    v_mfma_f32_32x32x16_bf16 v[32:47], a[16:19], v[100:103], v[32:47]
    v_mfma_f32_32x32x16_bf16 v[48:63], a[20:23], v[96:99], v[48:63]
    buffer_load_dword v126, v2, s[44:47], s65 offen sc1
    v_mfma_f32_32x32x16_bf16 v[64:79], a[20:23], v[100:103], v[64:79]
    s_waitcnt vmcnt(25)
    v_mfma_f32_32x32x16_bf16 v[16:31], a[24:27], v[104:107], v[16:31]
    buffer_load_dwordx4 v14, s[52:55], s76 offen offset:2048 lds
    v_mfma_f32_32x32x16_bf16 v[32:47], a[24:27], v[108:111], v[32:47]
    v_mfma_f32_32x32x16_bf16 v[48:63], a[28:31], v[104:107], v[48:63]
    buffer_load_dwordx4 v15, s[52:55], s76 offen offset:3072 lds
    v_mfma_f32_32x32x16_bf16 v[64:79], a[28:31], v[108:111], v[64:79]
    s_waitcnt vmcnt(25)
    v_mfma_f32_32x32x16_bf16 v[16:31], a[32:35], v[112:115], v[16:31]
    s_add_u32 m0, s20, 12288
    s_add_u32 s76, s73, 387072
    buffer_load_dwordx4 v12, s[52:55], s76 offen offset:0 lds
    v_mfma_f32_32x32x16_bf16 v[32:47], a[32:35], v[116:119], v[32:47]
    v_mfma_f32_32x32x16_bf16 v[48:63], a[36:39], v[112:115], v[48:63]
    buffer_load_dwordx4 v13, s[52:55], s76 offen offset:1024 lds
    v_mfma_f32_32x32x16_bf16 v[64:79], a[36:39], v[116:119], v[64:79]
    s_waitcnt vmcnt(25)
    v_mfma_f32_32x32x16_bf16 v[16:31], a[40:43], v[240:243], v[16:31]
    buffer_load_dwordx4 a[0:3], v124, s[44:47], s35 offen offset:1024 sc1
    v_mfma_f32_32x32x16_bf16 v[32:47], a[40:43], v[244:247], v[32:47]
    v_mfma_f32_32x32x16_bf16 v[48:63], a[44:47], v[240:243], v[48:63]
    buffer_load_dwordx4 a[4:7], v124, s[44:47], s25 offen offset:1024 sc1
    v_mfma_f32_32x32x16_bf16 v[64:79], a[44:47], v[244:247], v[64:79]
    s_waitcnt vmcnt(7)
    v_cmp_eq_u32 vcc, s3, v121
    s_nop 0
    s_cmp_eq_u64 vcc, -1
    s_cbranch_scc1 FK_23
    s_mov_b32 s92, 30000
SP_24:
    buffer_load_dword v121, v3, s[44:47], s51 offen sc1
    s_waitcnt vmcnt(0)
    v_cmp_eq_u32 vcc, s3, v121
    s_nop 0
    s_cmp_eq_u64 vcc, -1
    s_cbranch_scc1 SD_25
    s_sub_u32 s92, s92, 1
    s_cmp_eq_u32 s92, 0
    s_cbranch_scc0 SP_24
SD_25:
FK_23:
    s_waitcnt vmcnt(6)
    v_cmp_eq_u32 vcc, s3, v126
    s_nop 0
    s_cmp_eq_u64 vcc, -1
    s_cbranch_scc1 FK_26
    s_mov_b32 s92, 30000
SP_27:
    buffer_load_dword v126, v2, s[44:47], s65 offen sc1
    s_waitcnt vmcnt(0)
    v_cmp_eq_u32 vcc, s3, v126
    s_nop 0
    s_cmp_eq_u64 vcc, -1
    s_cbranch_scc1 SD_28
    s_sub_u32 s92, s92, 1
    s_cmp_eq_u32 s92, 0
    s_cbranch_scc0 SP_27
SD_28:
FK_26:
    v_mfma_f32_32x32x16_bf16 v[16:31], a[48:51], a[224:227], v[16:31]
    buffer_load_dwordx4 v[128:131], v124, s[44:47], s50 offen offset:0 sc1
    v_mfma_f32_32x32x16_bf16 v[32:47], a[48:51], a[228:231], v[32:47]
    buffer_load_dwordx4 v[132:135], v124, s[44:47], s50 offen offset:1024 sc1
    v_mfma_f32_32x32x16_bf16 v[48:63], a[52:55], a[224:227], v[48:63]
    buffer_load_dwordx4 v[136:139], v124, s[44:47], s50 offen offset:2048 sc1
    v_mfma_f32_32x32x16_bf16 v[64:79], a[52:55], a[228:231], v[64:79]
    v_mfma_f32_32x32x16_bf16 v[16:31], a[56:59], a[232:235], v[16:31]
    buffer_load_dwordx4 v[140:143], v124, s[44:47], s50 offen offset:3072 sc1
    s_waitcnt vmcnt(6)
    ds_read_b64_tr_b16 a[168:169], v122 offset:0
    ds_read_b64_tr_b16 a[170:171], v122 offset:1024
    v_mfma_f32_32x32x16_bf16 v[32:47], a[56:59], a[236:239], v[32:47]
    buffer_load_dwordx4 v[208:211], v124, s[44:47], s48 offen offset:0 sc1
    ds_read_b64_tr_b16 a[172:173], v123 offset:0
    ds_read_b64_tr_b16 a[174:175], v123 offset:1024
    v_mfma_f32_32x32x16_bf16 v[48:63], a[60:63], a[232:235], v[48:63]
    buffer_load_dwordx4 v[212:215], v124, s[44:47], s49 offen offset:0 sc1
    ds_read_b64_tr_b16 a[176:177], v122 offset:2048
    ds_read_b64_tr_b16 a[178:179], v122 offset:3072
    ds_read_b64_tr_b16 a[180:181], v123 offset:2048
    v_mfma_f32_32x32x16_bf16 v[64:79], a[60:63], a[236:239], v[64:79]
    ds_read_b64_tr_b16 a[182:183], v123 offset:3072
    ds_read_b64_tr_b16 a[184:185], v122 offset:4096
    v_mfma_f32_32x32x16_bf16 v[16:31], a[64:67], a[240:243], v[16:31]
    buffer_load_dwordx4 v[216:219], v124, s[44:47], s48 offen offset:1024 sc1
    ds_read_b64_tr_b16 a[186:187], v122 offset:5120
    ds_read_b64_tr_b16 a[188:189], v123 offset:4096
    ds_read_b64_tr_b16 a[190:191], v123 offset:5120
    v_mfma_f32_32x32x16_bf16 v[32:47], a[64:67], a[244:247], v[32:47]
    buffer_load_dwordx4 v[220:223], v124, s[44:47], s49 offen offset:1024 sc1
    ds_read_b64_tr_b16 a[192:193], v122 offset:6144
    ds_read_b64_tr_b16 a[194:195], v122 offset:7168
    v_mfma_f32_32x32x16_bf16 v[48:63], a[68:71], a[240:243], v[48:63]
    buffer_load_dwordx4 a[8:11], v124, s[44:47], s35 offen offset:2048 sc1
    ds_read_b64_tr_b16 a[196:197], v123 offset:6144
    ds_read_b64_tr_b16 a[198:199], v123 offset:7168
    ds_read_b64_tr_b16 a[200:201], v122 offset:8192
    v_mfma_f32_32x32x16_bf16 v[64:79], a[68:71], a[244:247], v[64:79]
    ds_read_b64_tr_b16 a[202:203], v122 offset:9216
    ds_read_b64_tr_b16 a[204:205], v123 offset:8192
    v_mfma_f32_32x32x16_bf16 v[16:31], a[72:75], a[248:251], v[16:31]
    buffer_load_dwordx4 a[12:15], v124, s[44:47], s25 offen offset:2048 sc1
    ds_read_b64_tr_b16 a[206:207], v123 offset:9216
    ds_read_b64_tr_b16 a[208:209], v122 offset:10240
    ds_read_b64_tr_b16 a[210:211], v122 offset:11264
    v_mfma_f32_32x32x16_bf16 v[32:47], a[72:75], a[252:255], v[32:47]
    buffer_load_dwordx4 v[144:147], v124, s[44:47], s41 offen offset:0 sc1
    ds_read_b64_tr_b16 a[212:213], v123 offset:10240
    ds_read_b64_tr_b16 a[214:215], v123 offset:11264
    v_mfma_f32_32x32x16_bf16 v[48:63], a[76:79], a[248:251], v[48:63]
    buffer_load_dwordx4 v[148:151], v124, s[44:47], s41 offen offset:1024 sc1
    ds_read_b64_tr_b16 a[216:217], v122 offset:12288
    ds_read_b64_tr_b16 a[218:219], v122 offset:13312
    v_mfma_f32_32x32x16_bf16 v[64:79], a[76:79], a[252:255], v[64:79]
    ds_read_b64_tr_b16 a[220:221], v123 offset:12288
    ds_read_b64_tr_b16 a[222:223], v123 offset:13312
    v_mfma_f32_32x32x16_bf16 v[16:31], a[80:83], v[176:179], v[16:31]
    buffer_load_dwordx4 v[152:155], v124, s[44:47], s41 offen offset:2048 sc1
    s_waitcnt lgkmcnt(0)
    s_waitcnt vmcnt(9)
    v_cvt_pk_bf16_f32 v128, v128, v129
    v_cvt_pk_bf16_f32 v129, v130, v131
    v_mfma_f32_32x32x16_bf16 v[32:47], a[80:83], v[180:183], v[32:47]
    buffer_load_dwordx4 v[156:159], v124, s[44:47], s41 offen offset:3072 sc1
    ds_write_b64 v127, v[128:129] offset:0
    v_cvt_pk_bf16_f32 v132, v132, v133
    v_cvt_pk_bf16_f32 v133, v134, v135
    v_mfma_f32_32x32x16_bf16 v[48:63], a[84:87], v[176:179], v[48:63]
    s_add_u32 m0, s74, 4096
    s_add_u32 s76, s75, 28672
    buffer_load_dwordx4 v12, s[56:59], s76 offen offset:0 lds
    ds_write_b64 v127, v[132:133] offset:512
    v_cvt_pk_bf16_f32 v136, v136, v137
    v_cvt_pk_bf16_f32 v137, v138, v139
    ds_write_b64 v127, v[136:137] offset:1024
    v_mfma_f32_32x32x16_bf16 v[64:79], a[84:87], v[180:183], v[64:79]
    v_cvt_pk_bf16_f32 v140, v140, v141
    v_cvt_pk_bf16_f32 v141, v142, v143
    ds_write_b64 v127, v[140:141] offset:1536
    v_mfma_f32_32x32x16_bf16 v[16:31], a[88:91], v[184:187], v[16:31]
    buffer_load_dwordx4 v13, s[56:59], s76 offen offset:1024 lds
    s_waitcnt lgkmcnt(0)
    ds_read_b64_tr_b16 v[80:81], v125 offset:0
    v_mfma_f32_32x32x16_bf16 v[32:47], a[88:91], v[188:191], v[32:47]
    buffer_load_dwordx4 v14, s[56:59], s76 offen offset:2048 lds
    ds_read_b64_tr_b16 v[82:83], v125 offset:512
    ds_read_b64_tr_b16 v[84:85], v125 offset:1024
    v_mfma_f32_32x32x16_bf16 v[48:63], a[92:95], v[184:187], v[48:63]
    buffer_load_dwordx4 v15, s[56:59], s76 offen offset:3072 lds
    ds_read_b64_tr_b16 v[86:87], v125 offset:1536
    v_mov_b32 v115, 0
    v_mfma_f32_32x32x16_bf16 v[64:79], a[92:95], v[188:191], v[64:79]
    v_mov_b32 v123, 0
    v_mfma_f32_32x32x16_bf16 v[16:31], a[96:99], v[192:195], v[16:31]
    buffer_load_dwordx4 v[224:227], v124, s[44:47], s48 offen offset:2048 sc1
    s_waitcnt vmcnt(11)
    v_mov_b32 v160, 0
    v_cndmask_b32 v162, 0, v218, s[94:95]
    v_cndmask_b32 v218, v218, 0, s[94:95]
    v_mfma_f32_32x32x16_bf16 v[32:47], a[96:99], v[196:199], v[32:47]
    buffer_load_dwordx4 v[228:231], v124, s[44:47], s49 offen offset:2048 sc1
    v_mov_b32 v161, 0
    v_cndmask_b32 v163, 0, v219, s[94:95]
    v_cndmask_b32 v219, v219, 0, s[94:95]
    v_mfma_f32_32x32x16_bf16 v[48:63], a[100:103], v[192:195], v[48:63]
    buffer_load_dwordx4 v[232:235], v124, s[44:47], s48 offen offset:3072 sc1
    v_mov_b32 v164, 0
    v_cndmask_b32 v166, 0, v222, s[94:95]
    v_cndmask_b32 v222, v222, 0, s[94:95]
    v_mfma_f32_32x32x16_bf16 v[64:79], a[100:103], v[196:199], v[64:79]
    v_mov_b32 v165, 0
    v_cndmask_b32 v167, 0, v223, s[94:95]
    v_cndmask_b32 v223, v223, 0, s[94:95]
    s_waitcnt lgkmcnt(0)
    v_mfma_f32_32x32x16_bf16 v[176:191], v[80:83], v[208:211], 0
    buffer_load_dwordx4 v[236:239], v124, s[44:47], s49 offen offset:3072 sc1
    ds_read_b64_tr_b16 v[240:241], v8 offset:0
    ds_read_b64_tr_b16 v[242:243], v8 offset:1024
    s_waitcnt vmcnt(8)
    v_cvt_pk_bf16_f32 v144, v144, v145
    v_mfma_f32_32x32x16_bf16 v[192:207], v[80:83], v[212:215], 0
    ds_read_b64_tr_b16 v[244:245], v9 offset:0
    ds_read_b64_tr_b16 v[246:247], v9 offset:1024
    v_cvt_pk_bf16_f32 v145, v146, v147
    ds_write_b64 v127, v[144:145] offset:2048
    v_mfma_f32_32x32x16_bf16 v[176:191], v[84:87], v[216:219], v[176:191]
    buffer_load_dwordx4 a[224:227], v124, s[44:47], s35 offen offset:3072 sc1
    ds_read_b64_tr_b16 v[248:249], v8 offset:2048
    ds_read_b64_tr_b16 v[250:251], v10 offset:3072
    v_cvt_pk_bf16_f32 v148, v148, v149
    v_cvt_pk_bf16_f32 v149, v150, v151
    v_mfma_f32_32x32x16_bf16 v[192:207], v[84:87], v[220:223], v[192:207]
    ds_read_b64_tr_b16 v[252:253], v9 offset:2048
    ds_read_b64_tr_b16 v[254:255], v11 offset:3072
    ds_write_b64 v127, v[148:149] offset:2560
    v_mfma_f32_32x32x16_bf16 v[16:31], a[104:107], a[0:3], v[16:31]
    buffer_load_dwordx4 a[228:231], v124, s[44:47], s25 offen offset:3072 sc1
    s_nop 1
    v_add_f32 v4, s93, v191
    v_rcp_f32 v4, v4
    s_nop 0
    v_mul_f32 v176, v176, v4
    v_mul_f32 v177, v177, v4
    v_mul_f32 v178, v178, v4
    v_mfma_f32_32x32x16_bf16 v[32:47], a[104:107], a[4:7], v[32:47]
    buffer_load_dwordx4 v[128:131], v124, s[44:47], s99 offen offset:0 sc1
    v_mul_f32 v179, v179, v4
    v_cvt_pk_bf16_f32 v108, v176, v177
    v_mul_f32 v180, v180, v4
    v_mul_f32 v181, v181, v4
    v_cvt_pk_bf16_f32 v109, v178, v179
    v_mul_f32 v182, v182, v4
    v_mfma_f32_32x32x16_bf16 v[48:63], a[108:111], a[0:3], v[48:63]
    v_mul_f32 v183, v183, v4
    v_cvt_pk_bf16_f32 v110, v180, v181
    v_mul_f32 v184, v184, v4
    v_mul_f32 v185, v185, v4
    v_cvt_pk_bf16_f32 v111, v182, v183
    v_mul_f32 v186, v186, v4
    v_mfma_f32_32x32x16_bf16 v[64:79], a[108:111], a[4:7], v[64:79]
    buffer_load_dwordx4 v[132:135], v124, s[44:47], s99 offen offset:1024 sc1
    v_mul_f32 v187, v187, v4
    v_cvt_pk_bf16_f32 v112, v184, v185
    v_mul_f32 v188, v188, v4
    v_mul_f32 v189, v189, v4
    v_cvt_pk_bf16_f32 v113, v186, v187
    v_cvt_pk_bf16_f32 v114, v188, v189
    v_mfma_f32_32x32x16_bf16 v[16:31], a[112:115], a[8:11], v[16:31]
    buffer_load_dwordx4 v[136:139], v124, s[44:47], s99 offen offset:2048 sc1
    v_add_f32 v5, s93, v207
    v_rcp_f32 v5, v5
    s_nop 0
    v_mul_f32 v192, v192, v5
    v_mul_f32 v193, v193, v5
    v_mul_f32 v194, v194, v5
    v_mul_f32 v195, v195, v5
    v_mfma_f32_32x32x16_bf16 v[32:47], a[112:115], a[12:15], v[32:47]
    v_cvt_pk_bf16_f32 v116, v192, v193
    v_mul_f32 v196, v196, v5
    v_mul_f32 v197, v197, v5
    v_cvt_pk_bf16_f32 v117, v194, v195
    v_mul_f32 v198, v198, v5
    v_mul_f32 v199, v199, v5
    v_mfma_f32_32x32x16_bf16 v[48:63], a[116:119], a[8:11], v[48:63]
    buffer_load_dwordx4 v[140:143], v124, s[44:47], s99 offen offset:3072 sc1
    v_cvt_pk_bf16_f32 v118, v196, v197
    v_mul_f32 v200, v200, v5
    v_mul_f32 v201, v201, v5
    v_cvt_pk_bf16_f32 v119, v198, v199
    v_mul_f32 v202, v202, v5
    v_mul_f32 v203, v203, v5
    v_mfma_f32_32x32x16_bf16 v[64:79], a[116:119], a[12:15], v[64:79]
    v_cvt_pk_bf16_f32 v120, v200, v201
    v_mul_f32 v204, v204, v5
    v_mul_f32 v205, v205, v5
    v_cvt_pk_bf16_f32 v121, v202, v203
    v_cvt_pk_bf16_f32 v122, v204, v205
    s_waitcnt lgkmcnt(1)
    v_mfma_f32_32x32x16_bf16 a[16:31], v[240:243], v[108:111], 0
    buffer_load_dwordx4 a[232:235], v124, s[44:47], s36 offen offset:0 sc1
    v_cvt_pk_bf16_f32 v152, v152, v153
    v_cvt_pk_bf16_f32 v153, v154, v155
    ds_write_b64 v127, v[152:153] offset:3072
    v_mfma_f32_32x32x16_bf16 a[32:47], v[240:243], v[116:119], 0
    buffer_load_dwordx4 a[236:239], v124, s[44:47], s72 offen offset:0 sc1
    v_cvt_pk_bf16_f32 v156, v156, v157
    v_cvt_pk_bf16_f32 v157, v158, v159
    ds_write_b64 v127, v[156:157] offset:3584
    v_mfma_f32_32x32x16_bf16 a[48:63], v[244:247], v[108:111], 0
    buffer_load_dwordx4 v[208:211], v124, s[44:47], s5 offen offset:0 sc1
    s_waitcnt vmcnt(9)
    v_mov_b32 v168, 0
    v_mov_b32 v170, v234
    v_mfma_f32_32x32x16_bf16 a[64:79], v[244:247], v[116:119], 0
    v_mov_b32 v234, 0
    v_mov_b32 v169, 0
    v_mov_b32 v171, v235
    v_mfma_f32_32x32x16_bf16 a[16:31], v[248:251], v[112:115], a[16:31]
    buffer_load_dwordx4 v[212:215], v124, s[44:47], s81 offen offset:0 sc1
    v_mov_b32 v235, 0
    v_mov_b32 v172, 0
    v_mov_b32 v174, v238
    v_mfma_f32_32x32x16_bf16 a[32:47], v[248:251], v[120:123], a[32:47]
    buffer_load_dwordx4 v[216:219], v124, s[44:47], s5 offen offset:1024 sc1
    v_mov_b32 v238, 0
    v_mov_b32 v173, 0
    v_mov_b32 v175, v239
    v_mfma_f32_32x32x16_bf16 a[48:63], v[252:255], v[112:115], a[48:63]
    buffer_load_dwordx4 v[220:223], v124, s[44:47], s81 offen offset:1024 sc1
    v_mov_b32 v239, 0
    s_waitcnt lgkmcnt(0)
    ds_read_b64_tr_b16 v[88:89], v125 offset:2048
    v_mfma_f32_32x32x16_bf16 a[64:79], v[252:255], v[120:123], a[64:79]
    ds_read_b64_tr_b16 v[90:91], v125 offset:2560
    ds_read_b64_tr_b16 v[92:93], v125 offset:3072
    ds_read_b64_tr_b16 v[94:95], v125 offset:3584
    s_waitcnt lgkmcnt(0)
    v_mfma_f32_32x32x16_bf16 v[176:191], v[84:87], v[160:163], 0
    s_add_u32 m0, s74, 8192
    s_add_u32 s76, s75, 57344
    buffer_load_dwordx4 v12, s[56:59], s76 offen offset:0 lds
    ds_read_b64_tr_b16 v[240:241], v8 offset:3584
    s_waitcnt vmcnt(7)
    v_cvt_pk_bf16_f32 v128, v128, v129
    v_cvt_pk_bf16_f32 v129, v130, v131
    v_mfma_f32_32x32x16_bf16 v[192:207], v[84:87], v[164:167], 0
    ds_read_b64_tr_b16 v[242:243], v8 offset:4608
    buffer_load_dwordx4 v13, s[56:59], s76 offen offset:1024 lds
    ds_write_b64 v127, v[128:129] offset:4096
    v_cvt_pk_bf16_f32 v132, v132, v133
    v_mfma_f32_32x32x16_bf16 v[176:191], v[88:91], v[224:227], v[176:191]
    ds_read_b64_tr_b16 v[244:245], v9 offset:3584
    ds_read_b64_tr_b16 v[246:247], v9 offset:4608
    v_cvt_pk_bf16_f32 v133, v134, v135
    ds_write_b64 v127, v[132:133] offset:4608
    v_mfma_f32_32x32x16_bf16 v[192:207], v[88:91], v[228:231], v[192:207]
    ds_read_b64_tr_b16 v[248:249], v8 offset:5632
    buffer_load_dwordx4 v14, s[56:59], s76 offen offset:2048 lds
    v_cvt_pk_bf16_f32 v136, v136, v137
    v_cvt_pk_bf16_f32 v137, v138, v139
    v_mfma_f32_32x32x16_bf16 v[176:191], v[92:95], v[232:235], v[176:191]
    ds_read_b64_tr_b16 v[250:251], v10 offset:6656
    ds_read_b64_tr_b16 v[252:253], v9 offset:5632
    ds_write_b64 v127, v[136:137] offset:5120
    v_cvt_pk_bf16_f32 v140, v140, v141
    v_mfma_f32_32x32x16_bf16 v[192:207], v[92:95], v[236:239], v[192:207]
    ds_read_b64_tr_b16 v[254:255], v11 offset:6656
    v_cvt_pk_bf16_f32 v141, v142, v143
    ds_write_b64 v127, v[140:141] offset:5632
    v_mfma_f32_32x32x16_bf16 v[16:31], a[120:123], a[224:227], v[16:31]
    buffer_load_dwordx4 v15, s[56:59], s76 offen offset:3072 lds
    s_nop 1
    v_add_f32 v4, s93, v191
    v_rcp_f32 v4, v4
    s_nop 0
    v_mul_f32 v176, v176, v4
    v_mul_f32 v177, v177, v4
    v_mul_f32 v178, v178, v4
    v_mfma_f32_32x32x16_bf16 v[32:47], a[120:123], a[228:231], v[32:47]
    v_mul_f32 v179, v179, v4
    v_cvt_pk_bf16_f32 v108, v176, v177
    v_mul_f32 v180, v180, v4
    v_mul_f32 v181, v181, v4
    v_cvt_pk_bf16_f32 v109, v178, v179
    v_mul_f32 v182, v182, v4
    v_mfma_f32_32x32x16_bf16 v[48:63], a[124:127], a[224:227], v[48:63]
    buffer_load_dwordx4 a[240:243], v124, s[44:47], s36 offen offset:1024 sc1
    v_mul_f32 v183, v183, v4
    v_cvt_pk_bf16_f32 v110, v180, v181
    v_mul_f32 v184, v184, v4
    v_mul_f32 v185, v185, v4
    v_cvt_pk_bf16_f32 v111, v182, v183
    v_mul_f32 v186, v186, v4
    v_mfma_f32_32x32x16_bf16 v[64:79], a[124:127], a[228:231], v[64:79]
    v_mul_f32 v187, v187, v4
    v_cvt_pk_bf16_f32 v112, v184, v185
    v_mul_f32 v188, v188, v4
    v_mul_f32 v189, v189, v4
    v_cvt_pk_bf16_f32 v113, v186, v187
    v_cvt_pk_bf16_f32 v114, v188, v189
    s_waitcnt vmcnt(9)
    v_mfma_f32_32x32x16_bf16 v[16:31], a[128:131], a[232:235], v[16:31]
    buffer_load_dwordx4 a[244:247], v124, s[44:47], s72 offen offset:1024 sc1
    v_add_f32 v5, s93, v207
    v_rcp_f32 v5, v5
    s_nop 0
    v_mul_f32 v192, v192, v5
    v_mul_f32 v193, v193, v5
    v_mul_f32 v194, v194, v5
    v_mul_f32 v195, v195, v5
    v_mfma_f32_32x32x16_bf16 v[32:47], a[128:131], a[236:239], v[32:47]
    v_cvt_pk_bf16_f32 v116, v192, v193
    v_mul_f32 v196, v196, v5
    v_mul_f32 v197, v197, v5
    v_cvt_pk_bf16_f32 v117, v194, v195
    v_mul_f32 v198, v198, v5
    v_mul_f32 v199, v199, v5
    v_mfma_f32_32x32x16_bf16 v[48:63], a[132:135], a[232:235], v[48:63]
    buffer_load_dwordx4 a[248:251], v124, s[44:47], s36 offen offset:2048 sc1
    v_cvt_pk_bf16_f32 v118, v196, v197
    v_mul_f32 v200, v200, v5
    v_mul_f32 v201, v201, v5
    v_cvt_pk_bf16_f32 v119, v198, v199
    v_mul_f32 v202, v202, v5
    v_mul_f32 v203, v203, v5
    v_mfma_f32_32x32x16_bf16 v[64:79], a[132:135], a[236:239], v[64:79]
    v_cvt_pk_bf16_f32 v120, v200, v201
    v_mul_f32 v204, v204, v5
    v_mul_f32 v205, v205, v5
    v_cvt_pk_bf16_f32 v121, v202, v203
    v_cvt_pk_bf16_f32 v122, v204, v205
    s_waitcnt lgkmcnt(1)
    v_mfma_f32_32x32x16_bf16 a[16:31], v[240:243], v[108:111], a[16:31]
    buffer_load_dwordx4 a[252:255], v124, s[44:47], s72 offen offset:2048 sc1
    s_waitcnt lgkmcnt(0)
    ds_read_b64_tr_b16 v[96:97], v125 offset:4096
    ds_read_b64_tr_b16 v[98:99], v125 offset:4608
    v_mfma_f32_32x32x16_bf16 a[32:47], v[240:243], v[116:119], a[32:47]
    buffer_load_dwordx4 v[144:147], v124, s[44:47], s4 offen offset:0 sc1
    ds_read_b64_tr_b16 v[100:101], v125 offset:5120
    ds_read_b64_tr_b16 v[102:103], v125 offset:5632
    v_mfma_f32_32x32x16_bf16 a[48:63], v[244:247], v[108:111], a[48:63]
    buffer_load_dwordx4 v[148:151], v124, s[44:47], s4 offen offset:1024 sc1
    s_waitcnt vmcnt(10)
    v_mov_b32 v162, 0
    v_mfma_f32_32x32x16_bf16 a[64:79], v[244:247], v[116:119], a[64:79]
    v_cndmask_b32 v160, v216, 0, s[94:95]
    v_cndmask_b32 v216, 0, v216, s[94:95]
    v_mfma_f32_32x32x16_bf16 a[16:31], v[248:251], v[112:115], a[16:31]
    s_add_u32 m0, s74, 12288
    s_add_u32 s76, s75, 86016
    buffer_load_dwordx4 v12, s[56:59], s76 offen offset:0 lds
    v_mov_b32 v163, 0
    v_cndmask_b32 v161, v217, 0, s[94:95]
    v_cndmask_b32 v217, 0, v217, s[94:95]
    v_mfma_f32_32x32x16_bf16 a[32:47], v[248:251], v[120:123], a[32:47]
    buffer_load_dwordx4 v13, s[56:59], s76 offen offset:1024 lds
    v_mov_b32 v166, 0
    v_cndmask_b32 v164, v220, 0, s[94:95]
    v_mfma_f32_32x32x16_bf16 a[48:63], v[252:255], v[112:115], a[48:63]
    buffer_load_dwordx4 v[224:227], v124, s[44:47], s5 offen offset:2048 sc1
    v_cndmask_b32 v220, 0, v220, s[94:95]
    v_mov_b32 v167, 0
    v_mfma_f32_32x32x16_bf16 a[64:79], v[252:255], v[120:123], a[64:79]
    v_cndmask_b32 v165, v221, 0, s[94:95]
    v_cndmask_b32 v221, 0, v221, s[94:95]
    s_waitcnt vmcnt(9) lgkmcnt(0)
    v_mfma_f32_32x32x16_bf16 v[176:191], v[92:95], v[168:171], 0
    buffer_load_dwordx4 v[228:231], v124, s[44:47], s81 offen offset:2048 sc1
    ds_read_b64_tr_b16 v[240:241], v8 offset:7168
    s_waitcnt vmcnt(4)
    s_nop 0
    v_cvt_pk_bf16_f32 v144, v144, v145
    v_mfma_f32_32x32x16_bf16 v[192:207], v[92:95], v[172:175], 0
    ds_read_b64_tr_b16 v[242:243], v8 offset:8192
    buffer_load_dwordx4 a[80:83], v124, s[44:47], s36 offen offset:3072 sc1
    v_cvt_pk_bf16_f32 v145, v146, v147
    v_mfma_f32_32x32x16_bf16 v[176:191], v[96:99], v[208:211], v[176:191]
    ds_read_b64_tr_b16 v[244:245], v9 offset:7168
    ds_read_b64_tr_b16 v[246:247], v9 offset:8192
    ds_write_b64 v127, v[144:145] offset:6144
    v_mfma_f32_32x32x16_bf16 v[192:207], v[96:99], v[212:215], v[192:207]
    ds_read_b64_tr_b16 v[248:249], v8 offset:9216
    buffer_load_dwordx4 a[84:87], v124, s[44:47], s72 offen offset:3072 sc1
    v_cvt_pk_bf16_f32 v148, v148, v149
    v_mfma_f32_32x32x16_bf16 v[176:191], v[100:103], v[160:163], v[176:191]
    ds_read_b64_tr_b16 v[250:251], v10 offset:10240
    ds_read_b64_tr_b16 v[252:253], v9 offset:9216
    v_cvt_pk_bf16_f32 v149, v150, v151
    v_mfma_f32_32x32x16_bf16 v[192:207], v[100:103], v[164:167], v[192:207]
    ds_read_b64_tr_b16 v[254:255], v11 offset:10240
    ds_write_b64 v127, v[148:149] offset:6656
    v_mfma_f32_32x32x16_bf16 v[16:31], a[136:139], a[240:243], v[16:31]
    buffer_load_dwordx4 a[88:91], v124, s[44:47], s37 offen offset:0 sc1
    s_nop 1
    s_nop 1
    v_add_f32 v4, s93, v191
    v_rcp_f32 v4, v4
    s_nop 0
    v_mul_f32 v176, v176, v4
    v_mul_f32 v177, v177, v4
    v_mul_f32 v178, v178, v4
    v_mfma_f32_32x32x16_bf16 v[32:47], a[136:139], a[244:247], v[32:47]
    v_mul_f32 v179, v179, v4
    v_cvt_pk_bf16_f32 v108, v176, v177
    v_mul_f32 v180, v180, v4
    v_mul_f32 v181, v181, v4
    v_cvt_pk_bf16_f32 v109, v178, v179
    v_mul_f32 v182, v182, v4
    v_mfma_f32_32x32x16_bf16 v[48:63], a[140:143], a[240:243], v[48:63]
    buffer_load_dwordx4 a[92:95], v124, s[44:47], s83 offen offset:0 sc1
    v_mul_f32 v183, v183, v4
    v_cvt_pk_bf16_f32 v110, v180, v181
    v_mul_f32 v184, v184, v4
    v_mul_f32 v185, v185, v4
    v_cvt_pk_bf16_f32 v111, v182, v183
    v_mul_f32 v186, v186, v4
    v_mfma_f32_32x32x16_bf16 v[64:79], a[140:143], a[244:247], v[64:79]
    v_mul_f32 v187, v187, v4
    v_cvt_pk_bf16_f32 v112, v184, v185
    v_mul_f32 v188, v188, v4
    v_mul_f32 v189, v189, v4
    v_cvt_pk_bf16_f32 v113, v186, v187
    v_cvt_pk_bf16_f32 v114, v188, v189
    v_mfma_f32_32x32x16_bf16 v[16:31], a[144:147], a[248:251], v[16:31]
    buffer_load_dwordx4 a[96:99], v124, s[44:47], s37 offen offset:1024 sc1
    v_add_f32 v5, s93, v207
    v_rcp_f32 v5, v5
    s_nop 0
    v_mul_f32 v192, v192, v5
    v_mul_f32 v193, v193, v5
    v_mul_f32 v194, v194, v5
    v_mul_f32 v195, v195, v5
    v_mfma_f32_32x32x16_bf16 v[32:47], a[144:147], a[252:255], v[32:47]
    v_cvt_pk_bf16_f32 v116, v192, v193
    v_mul_f32 v196, v196, v5
    v_mul_f32 v197, v197, v5
    v_cvt_pk_bf16_f32 v117, v194, v195
    v_mul_f32 v198, v198, v5
    v_mul_f32 v199, v199, v5
    v_mfma_f32_32x32x16_bf16 v[48:63], a[148:151], a[248:251], v[48:63]
    buffer_load_dwordx4 a[100:103], v124, s[44:47], s83 offen offset:1024 sc1
    v_cvt_pk_bf16_f32 v118, v196, v197
    v_mul_f32 v200, v200, v5
    v_mul_f32 v201, v201, v5
    v_cvt_pk_bf16_f32 v119, v198, v199
    v_mul_f32 v202, v202, v5
    v_mul_f32 v203, v203, v5
    v_mfma_f32_32x32x16_bf16 v[64:79], a[148:151], a[252:255], v[64:79]
    v_cvt_pk_bf16_f32 v120, v200, v201
    v_mul_f32 v204, v204, v5
    v_mul_f32 v205, v205, v5
    v_cvt_pk_bf16_f32 v121, v202, v203
    v_cvt_pk_bf16_f32 v122, v204, v205
    s_waitcnt lgkmcnt(1)
    v_mfma_f32_32x32x16_bf16 a[16:31], v[240:243], v[108:111], a[16:31]
    buffer_load_dwordx4 a[104:107], v124, s[44:47], s37 offen offset:2048 sc1
    s_waitcnt lgkmcnt(0)
    v_mfma_f32_32x32x16_bf16 a[32:47], v[240:243], v[116:119], a[32:47]
    buffer_load_dwordx4 a[108:111], v124, s[44:47], s83 offen offset:2048 sc1
    v_mfma_f32_32x32x16_bf16 a[48:63], v[244:247], v[108:111], a[48:63]
    buffer_load_dwordx4 a[112:115], v124, s[44:47], s37 offen offset:3072 sc1
    ds_read_b64_tr_b16 v[104:105], v125 offset:6144
    v_mfma_f32_32x32x16_bf16 a[64:79], v[244:247], v[116:119], a[64:79]
    v_mfma_f32_32x32x16_bf16 a[16:31], v[248:251], v[112:115], a[16:31]
    buffer_load_dwordx4 a[116:119], v124, s[44:47], s83 offen offset:3072 sc1
    v_mfma_f32_32x32x16_bf16 a[32:47], v[248:251], v[120:123], a[32:47]
    buffer_load_dwordx4 a[120:123], v124, s[44:47], s38 offen offset:0 sc1
    ds_read_b64_tr_b16 v[106:107], v125 offset:6656
    v_mfma_f32_32x32x16_bf16 a[48:63], v[252:255], v[112:115], a[48:63]
    buffer_load_dwordx4 a[124:127], v124, s[44:47], s85 offen offset:0 sc1
    v_mfma_f32_32x32x16_bf16 a[64:79], v[252:255], v[120:123], a[64:79]
    s_waitcnt vmcnt(12) lgkmcnt(0)
    s_nop 0
    v_mfma_f32_32x32x16_bf16 v[176:191], v[100:103], v[216:219], 0
    buffer_load_dwordx4 a[128:131], v124, s[44:47], s38 offen offset:1024 sc1
    ds_read_b64_tr_b16 v[240:241], v8 offset:10752
    ds_read_b64_tr_b16 v[242:243], v8 offset:11776
    v_mfma_f32_32x32x16_bf16 v[192:207], v[100:103], v[220:223], 0
    ds_read_b64_tr_b16 v[244:245], v9 offset:10752
    ds_read_b64_tr_b16 v[246:247], v9 offset:11776
    v_mfma_f32_32x32x16_bf16 v[176:191], v[104:107], v[224:227], v[176:191]
    buffer_load_dwordx4 a[132:135], v124, s[44:47], s85 offen offset:1024 sc1
    ds_read_b64_tr_b16 v[248:249], v8 offset:12800
    ds_read_b64_tr_b16 v[250:251], v10 offset:13824
    v_mfma_f32_32x32x16_bf16 v[192:207], v[104:107], v[228:231], v[192:207]
    ds_read_b64_tr_b16 v[252:253], v9 offset:12800
    ds_read_b64_tr_b16 v[254:255], v11 offset:13824
    s_waitcnt vmcnt(12)
    v_mfma_f32_32x32x16_bf16 v[16:31], a[152:155], a[80:83], v[16:31]
    buffer_load_dwordx4 a[136:139], v124, s[44:47], s38 offen offset:2048 sc1
    s_nop 3
    v_add_f32 v4, s93, v191
    v_rcp_f32 v4, v4
    s_nop 0
    v_mul_f32 v176, v176, v4
    v_mul_f32 v177, v177, v4
    v_mul_f32 v178, v178, v4
    v_mfma_f32_32x32x16_bf16 v[32:47], a[152:155], a[84:87], v[32:47]
    v_mul_f32 v179, v179, v4
    v_cvt_pk_bf16_f32 v108, v176, v177
    v_mul_f32 v180, v180, v4
    v_mul_f32 v181, v181, v4
    v_cvt_pk_bf16_f32 v109, v178, v179
    v_mul_f32 v182, v182, v4
    v_mfma_f32_32x32x16_bf16 v[48:63], a[156:159], a[80:83], v[48:63]
    buffer_load_dwordx4 a[140:143], v124, s[44:47], s85 offen offset:2048 sc1
    v_mul_f32 v183, v183, v4
    v_cvt_pk_bf16_f32 v110, v180, v181
    v_mul_f32 v184, v184, v4
    v_mul_f32 v185, v185, v4
    v_cvt_pk_bf16_f32 v111, v182, v183
    v_mul_f32 v186, v186, v4
    v_mfma_f32_32x32x16_bf16 v[64:79], a[156:159], a[84:87], v[64:79]
    v_mul_f32 v187, v187, v4
    v_cvt_pk_bf16_f32 v112, v184, v185
    v_mul_f32 v188, v188, v4
    v_mul_f32 v189, v189, v4
    v_cvt_pk_bf16_f32 v113, v186, v187
    v_cvt_pk_bf16_f32 v114, v188, v189
    s_waitcnt vmcnt(12)
    v_mfma_f32_32x32x16_bf16 v[16:31], a[160:163], a[88:91], v[16:31]
    buffer_load_dwordx4 a[144:147], v124, s[44:47], s38 offen offset:3072 sc1
    v_add_f32 v5, s93, v207
    v_rcp_f32 v5, v5
    s_nop 0
    v_mul_f32 v192, v192, v5
    v_mul_f32 v193, v193, v5
    v_mul_f32 v194, v194, v5
    v_mul_f32 v195, v195, v5
    v_mfma_f32_32x32x16_bf16 v[32:47], a[160:163], a[92:95], v[32:47]
    v_cvt_pk_bf16_f32 v116, v192, v193
    v_mul_f32 v196, v196, v5
    v_mul_f32 v197, v197, v5
    v_cvt_pk_bf16_f32 v117, v194, v195
    v_mul_f32 v198, v198, v5
    v_mul_f32 v199, v199, v5
    v_mfma_f32_32x32x16_bf16 v[48:63], a[164:167], a[88:91], v[48:63]
    buffer_load_dwordx4 a[148:151], v124, s[44:47], s85 offen offset:3072 sc1
    v_cvt_pk_bf16_f32 v118, v196, v197
    v_mul_f32 v200, v200, v5
    v_mul_f32 v201, v201, v5
    v_cvt_pk_bf16_f32 v119, v198, v199
    v_mul_f32 v202, v202, v5
    v_mul_f32 v203, v203, v5
    v_mfma_f32_32x32x16_bf16 v[64:79], a[164:167], a[92:95], v[64:79]
    v_cvt_pk_bf16_f32 v120, v200, v201
    v_mul_f32 v204, v204, v5
    v_mul_f32 v205, v205, v5
    v_cvt_pk_bf16_f32 v121, v202, v203
    v_cvt_pk_bf16_f32 v122, v204, v205
    s_waitcnt lgkmcnt(0)
    v_mfma_f32_32x32x16_bf16 a[16:31], v[240:243], v[108:111], a[16:31]
    v_and_b32 v4, 31, v1
    v_and_b32 v5, 7, v1
    v_bfe_u32 v6, v1, 2, 1
    v_lshl_or_b32 v5, v6, 3, v5
    v_lshrrev_b32 v6, 5, v1
    v_mfma_f32_32x32x16_bf16 a[32:47], v[240:243], v[116:119], a[32:47]
    v_xor_b32 v5, v5, v6
    v_lshlrev_b32 v5, 4, v5
    v_lshl_add_u32 v5, v4, 8, v5
    v_add_u32 v160, s20, v5
    v_xor_b32 v161, 32, v160
    v_mfma_f32_32x32x16_bf16 a[48:63], v[244:247], v[108:111], a[48:63]
    v_xor_b32 v162, 64, v160
    v_xor_b32 v163, 96, v160
    v_xor_b32 v164, 128, v160
    v_xor_b32 v165, 160, v160
    v_xor_b32 v166, 192, v160
    v_mfma_f32_32x32x16_bf16 a[64:79], v[244:247], v[116:119], a[64:79]
    v_xor_b32 v167, 224, v160
    v_lshrrev_b32 v4, 2, v0
    v_and_b32 v5, 7, v4
    v_bfe_u32 v6, v4, 2, 1
    v_lshl_or_b32 v5, v6, 3, v5
    v_mfma_f32_32x32x16_bf16 a[16:31], v[248:251], v[112:115], a[16:31]
    v_and_b32 v6, 3, v0
    v_lshlrev_b32 v7, 1, v6
    v_xor_b32 v5, v5, v7
    v_lshlrev_b32 v5, 4, v5
    v_lshl_add_u32 v168, v4, 8, v5
    v_mfma_f32_32x32x16_bf16 a[32:47], v[248:251], v[120:123], a[32:47]
    v_xor_b32_e64 v169, 16, v168
    v_xor_b32 v170, 128, v168
    v_xor_b32 v171, 144, v168
    v_add_u32 v172, 81920, v168
    v_add_u32 v173, 81920, v169
    v_mfma_f32_32x32x16_bf16 a[48:63], v[252:255], v[112:115], a[48:63]
    v_add_u32 v174, 81920, v170
    v_add_u32 v175, 81920, v171
    v_mul_u32_u24 v4, 896, v4
    v_lshl_add_u32 v12, v6, 4, v4
    s_mul_i32 s87, s77, 57344
    v_mfma_f32_32x32x16_bf16 a[64:79], v[252:255], v[120:123], a[64:79]
    s_lshl_b32 s88, s78, 7
    s_add_u32 s86, s87, s88
    buffer_load_dwordx4 v[128:131], v12, s[28:31], s86 offen offset:0
    buffer_load_dwordx4 v[132:135], v12, s[28:31], s86 offen offset:64
    s_waitcnt vmcnt(14)
    v_mfma_f32_32x32x16_bf16 v[16:31], a[168:171], a[96:99], v[16:31]
    v_mfma_f32_32x32x16_bf16 v[32:47], a[168:171], a[100:103], v[32:47]
    s_sub_u32 s87, s74, s20
    v_add_u32 v176, s87, v160
    v_add_u32 v177, s87, v161
    v_add_u32 v178, s87, v162
    v_add_u32 v179, s87, v163
    v_mfma_f32_32x32x16_bf16 v[48:63], a[172:175], a[96:99], v[48:63]
    v_add_u32 v180, s87, v164
    v_add_u32 v181, s87, v165
    v_add_u32 v182, s87, v166
    v_add_u32 v183, s87, v167
    v_mfma_f32_32x32x16_bf16 v[64:79], a[172:175], a[100:103], v[64:79]
    ds_write_b128 v160, a[16:19] offset:0
    ds_write_b128 v161, a[20:23] offset:0
    ds_write_b128 v162, a[24:27] offset:0
    ds_write_b128 v163, a[28:31] offset:0
    s_waitcnt vmcnt(12)
    v_mfma_f32_32x32x16_bf16 v[16:31], a[176:179], a[104:107], v[16:31]
    ds_write_b128 v160, a[32:35] offset:8192
    s_waitcnt vmcnt(0)
    ds_write_b128 v161, a[36:39] offset:8192
    v_lshlrev_b32 v136, 16, v128
    v_mfma_f32_32x32x16_bf16 v[32:47], a[176:179], a[108:111], v[32:47]
    v_and_b32 v137, 0xffff0000, v128
    ds_write_b128 v162, a[40:43] offset:8192
    v_lshlrev_b32 v138, 16, v129
    ds_write_b128 v163, a[44:47] offset:8192
    v_mfma_f32_32x32x16_bf16 v[48:63], a[180:183], a[104:107], v[48:63]
    v_and_b32 v139, 0xffff0000, v129
    v_lshlrev_b32 v140, 16, v130
    ds_write_b128 v164, a[48:51] offset:0
    v_and_b32 v141, 0xffff0000, v130
    v_mfma_f32_32x32x16_bf16 v[64:79], a[180:183], a[108:111], v[64:79]
    ds_write_b128 v165, a[52:55] offset:0
    v_lshlrev_b32 v142, 16, v131
    v_and_b32 v143, 0xffff0000, v131
    v_mfma_f32_32x32x16_bf16 v[16:31], a[184:187], a[112:115], v[16:31]
    ds_write_b128 v166, a[56:59] offset:0
    v_lshlrev_b32 v144, 16, v132
    ds_write_b128 v167, a[60:63] offset:0
    v_and_b32 v145, 0xffff0000, v132
    v_mfma_f32_32x32x16_bf16 v[32:47], a[184:187], a[116:119], v[32:47]
    ds_write_b128 v164, a[64:67] offset:8192
    v_lshlrev_b32 v146, 16, v133
    v_and_b32 v147, 0xffff0000, v133
    v_mfma_f32_32x32x16_bf16 v[48:63], a[188:191], a[112:115], v[48:63]
    ds_write_b128 v165, a[68:71] offset:8192
    v_lshlrev_b32 v148, 16, v134
    ds_write_b128 v166, a[72:75] offset:8192
    v_and_b32 v149, 0xffff0000, v134
    v_mfma_f32_32x32x16_bf16 v[64:79], a[188:191], a[116:119], v[64:79]
    ds_write_b128 v167, a[76:79] offset:8192
    v_lshlrev_b32 v150, 16, v135
    v_and_b32 v151, 0xffff0000, v135
    v_mfma_f32_32x32x16_bf16 v[16:31], a[192:195], a[120:123], v[16:31]
    v_mfma_f32_32x32x16_bf16 v[16:31], a[200:203], a[128:131], v[16:31]
    v_mfma_f32_32x32x16_bf16 v[16:31], a[208:211], a[136:139], v[16:31]
    v_mfma_f32_32x32x16_bf16 v[16:31], a[216:219], a[144:147], v[16:31]
    v_mfma_f32_32x32x16_bf16 v[32:47], a[192:195], a[124:127], v[32:47]
    v_mfma_f32_32x32x16_bf16 v[32:47], a[200:203], a[132:135], v[32:47]
    s_nop 9
    ds_write_b128 v176, v[16:19] offset:0
    ds_write_b128 v177, v[20:23] offset:0
    v_mfma_f32_32x32x16_bf16 v[32:47], a[208:211], a[140:143], v[32:47]
    ds_write_b128 v178, v[24:27] offset:0
    v_mfma_f32_32x32x16_bf16 v[32:47], a[216:219], a[148:151], v[32:47]
    ds_write_b128 v179, v[28:31] offset:0
    v_mfma_f32_32x32x16_bf16 v[48:63], a[196:199], a[120:123], v[48:63]
    v_mfma_f32_32x32x16_bf16 v[48:63], a[204:207], a[128:131], v[48:63]
    s_nop 8
    ds_write_b128 v176, v[32:35] offset:8192
    ds_write_b128 v177, v[36:39] offset:8192
    v_mfma_f32_32x32x16_bf16 v[48:63], a[212:215], a[136:139], v[48:63]
    ds_write_b128 v178, v[40:43] offset:8192
    v_mfma_f32_32x32x16_bf16 v[48:63], a[220:223], a[144:147], v[48:63]
    ds_write_b128 v179, v[44:47] offset:8192
    v_mfma_f32_32x32x16_bf16 v[64:79], a[196:199], a[124:127], v[64:79]
    v_mfma_f32_32x32x16_bf16 v[64:79], a[204:207], a[132:135], v[64:79]
    s_nop 8
    ds_write_b128 v180, v[48:51] offset:0
    ds_write_b128 v181, v[52:55] offset:0
    v_mfma_f32_32x32x16_bf16 v[64:79], a[212:215], a[140:143], v[64:79]
    ds_write_b128 v182, v[56:59] offset:0
    v_mfma_f32_32x32x16_bf16 v[64:79], a[220:223], a[148:151], v[64:79]
    ds_write_b128 v183, v[60:63] offset:0
    s_nop 10
    ds_write_b128 v180, v[64:67] offset:8192
    ds_write_b128 v181, v[68:71] offset:8192
    ds_write_b128 v182, v[72:75] offset:8192
    ds_write_b128 v183, v[76:79] offset:8192
    s_mov_b32 s94, 1.0
    s_mov_b32 s95, 1.0
    s_mov_b32 s96, 0x3fb8aa3b
    s_mov_b32 s97, 0x3fb8aa3b
    s_waitcnt lgkmcnt(0)
    s_barrier
    ds_read_b128 v[96:99], v168 offset:16384
    ds_read_b128 v[100:103], v169 offset:16384
    ds_read_b128 v[104:107], v170 offset:16384
    ds_read_b128 v[108:111], v171 offset:16384
    ds_read_b128 v[208:211], v172 offset:0
    ds_read_b128 v[212:215], v173 offset:0
    ds_read_b128 v[216:219], v174 offset:0
    ds_read_b128 v[220:223], v175 offset:0
    ds_read_b128 v[224:227], v172 offset:20480
    ds_read_b128 v[228:231], v173 offset:20480
    ds_read_b128 v[232:235], v174 offset:20480
    ds_read_b128 v[236:239], v175 offset:20480
    ds_read_b128 v[240:243], v172 offset:40960
    ds_read_b128 v[244:247], v173 offset:40960
    ds_read_b128 v[248:251], v174 offset:40960
    ds_read_b128 v[252:255], v175 offset:40960
    ds_read_b128 v[80:83], v168 offset:0
    ds_read_b128 v[84:87], v169 offset:0
    ds_read_b128 v[88:91], v170 offset:0
    ds_read_b128 v[92:95], v171 offset:0
    ds_read_b128 v[16:19], v168 offset:36864
    ds_read_b128 v[20:23], v169 offset:36864
    ds_read_b128 v[24:27], v170 offset:36864
    ds_read_b128 v[28:31], v171 offset:36864
    ds_read_b128 v[32:35], v168 offset:53248
    ds_read_b128 v[36:39], v169 offset:53248
    ds_read_b128 v[40:43], v170 offset:53248
    ds_read_b128 v[44:47], v171 offset:53248
    ds_read_b128 v[48:51], v172 offset:61440
    ds_read_b128 v[52:55], v173 offset:61440
    ds_read_b128 v[56:59], v174 offset:61440
    ds_read_b128 v[60:63], v175 offset:61440
    s_waitcnt lgkmcnt(15)
    s_nop 0
    v_pk_add_f32 v[96:97], v[96:97], v[208:209]
    v_pk_add_f32 v[98:99], v[98:99], v[210:211]
    v_pk_add_f32 v[100:101], v[100:101], v[212:213]
    v_pk_add_f32 v[102:103], v[102:103], v[214:215]
    v_pk_add_f32 v[104:105], v[104:105], v[216:217]
    v_pk_add_f32 v[106:107], v[106:107], v[218:219]
    v_pk_add_f32 v[108:109], v[108:109], v[220:221]
    v_pk_add_f32 v[110:111], v[110:111], v[222:223]
    v_pk_add_f32 v[96:97], v[96:97], v[224:225]
    v_pk_add_f32 v[98:99], v[98:99], v[226:227]
    v_pk_add_f32 v[100:101], v[100:101], v[228:229]
    v_pk_add_f32 v[102:103], v[102:103], v[230:231]
    v_pk_add_f32 v[104:105], v[104:105], v[232:233]
    v_pk_add_f32 v[106:107], v[106:107], v[234:235]
    v_pk_add_f32 v[108:109], v[108:109], v[236:237]
    v_pk_add_f32 v[110:111], v[110:111], v[238:239]
    v_pk_add_f32 v[96:97], v[96:97], v[240:241]
    v_pk_add_f32 v[98:99], v[98:99], v[242:243]
    v_pk_add_f32 v[100:101], v[100:101], v[244:245]
    v_pk_add_f32 v[102:103], v[102:103], v[246:247]
    v_pk_add_f32 v[104:105], v[104:105], v[248:249]
    v_pk_add_f32 v[106:107], v[106:107], v[250:251]
    v_pk_add_f32 v[108:109], v[108:109], v[252:253]
    v_pk_add_f32 v[110:111], v[110:111], v[254:255]
    v_exp_f32 v112, -v96
    v_exp_f32 v113, -v97
    v_exp_f32 v114, -v98
    v_exp_f32 v115, -v99
    v_exp_f32 v116, -v100
    v_exp_f32 v117, -v101
    v_exp_f32 v118, -v102
    v_exp_f32 v119, -v103
    v_exp_f32 v120, -v104
    v_exp_f32 v121, -v105
    v_exp_f32 v122, -v106
    v_exp_f32 v123, -v107
    v_exp_f32 v124, -v108
    v_exp_f32 v125, -v109
    v_exp_f32 v126, -v110
    v_exp_f32 v127, -v111
    s_waitcnt lgkmcnt(8)
    v_pk_add_f32 v[80:81], v[80:81], v[16:17]
    v_pk_add_f32 v[82:83], v[82:83], v[18:19]
    v_pk_add_f32 v[84:85], v[84:85], v[20:21]
    v_pk_add_f32 v[86:87], v[86:87], v[22:23]
    v_pk_add_f32 v[88:89], v[88:89], v[24:25]
    v_pk_add_f32 v[90:91], v[90:91], v[26:27]
    v_pk_add_f32 v[92:93], v[92:93], v[28:29]
    v_pk_add_f32 v[94:95], v[94:95], v[30:31]
    s_waitcnt lgkmcnt(4)
    v_pk_add_f32 v[80:81], v[80:81], v[32:33]
    v_pk_add_f32 v[82:83], v[82:83], v[34:35]
    v_pk_add_f32 v[84:85], v[84:85], v[36:37]
    v_pk_add_f32 v[86:87], v[86:87], v[38:39]
    v_pk_add_f32 v[88:89], v[88:89], v[40:41]
    v_pk_add_f32 v[90:91], v[90:91], v[42:43]
    v_pk_add_f32 v[92:93], v[92:93], v[44:45]
    v_pk_add_f32 v[94:95], v[94:95], v[46:47]
    s_waitcnt lgkmcnt(0)
    s_nop 0
    v_pk_add_f32 v[80:81], v[80:81], v[48:49]
    v_pk_add_f32 v[82:83], v[82:83], v[50:51]
    v_pk_add_f32 v[84:85], v[84:85], v[52:53]
    v_pk_add_f32 v[86:87], v[86:87], v[54:55]
    v_pk_add_f32 v[88:89], v[88:89], v[56:57]
    v_pk_add_f32 v[90:91], v[90:91], v[58:59]
    v_pk_add_f32 v[92:93], v[92:93], v[60:61]
    v_pk_add_f32 v[94:95], v[94:95], v[62:63]
    v_pk_mul_f32 v[80:81], v[80:81], v[96:97]
    v_pk_mul_f32 v[82:83], v[82:83], v[98:99]
    v_pk_mul_f32 v[84:85], v[84:85], v[100:101]
    v_pk_mul_f32 v[86:87], v[86:87], v[102:103]
    v_pk_fma_f32 v[112:113], v[112:113], s[96:97], s[96:97]
    v_pk_fma_f32 v[114:115], v[114:115], s[96:97], s[96:97]
    v_pk_fma_f32 v[116:117], v[116:117], s[96:97], s[96:97]
    v_pk_fma_f32 v[118:119], v[118:119], s[96:97], s[96:97]
    v_rcp_f32 v112, v112
    v_rcp_f32 v113, v113
    v_rcp_f32 v114, v114
    v_rcp_f32 v115, v115
    v_rcp_f32 v116, v116
    v_rcp_f32 v117, v117
    v_rcp_f32 v118, v118
    v_rcp_f32 v119, v119
    v_pk_fma_f32 v[136:137], v[80:81], v[112:113], v[136:137]
    v_pk_fma_f32 v[138:139], v[82:83], v[114:115], v[138:139]
    v_pk_fma_f32 v[140:141], v[84:85], v[116:117], v[140:141]
    v_pk_fma_f32 v[142:143], v[86:87], v[118:119], v[142:143]
    v_cvt_pk_bf16_f32 v128, v136, v137
    v_cvt_pk_bf16_f32 v129, v138, v139
    v_cvt_pk_bf16_f32 v130, v140, v141
    v_cvt_pk_bf16_f32 v131, v142, v143
    buffer_store_dwordx4 v[128:131], v12, s[60:63], s86 offen offset:0 sc1
    v_pk_mul_f32 v[88:89], v[88:89], v[104:105]
    v_pk_mul_f32 v[90:91], v[90:91], v[106:107]
    v_pk_mul_f32 v[92:93], v[92:93], v[108:109]
    v_pk_mul_f32 v[94:95], v[94:95], v[110:111]
    v_pk_fma_f32 v[120:121], v[120:121], s[96:97], s[96:97]
    v_pk_fma_f32 v[122:123], v[122:123], s[96:97], s[96:97]
    v_pk_fma_f32 v[124:125], v[124:125], s[96:97], s[96:97]
    v_pk_fma_f32 v[126:127], v[126:127], s[96:97], s[96:97]
    v_rcp_f32 v120, v120
    v_rcp_f32 v121, v121
    v_rcp_f32 v122, v122
    v_rcp_f32 v123, v123
    v_rcp_f32 v124, v124
    v_rcp_f32 v125, v125
    v_rcp_f32 v126, v126
    v_rcp_f32 v127, v127
    v_pk_fma_f32 v[144:145], v[88:89], v[120:121], v[144:145]
    v_pk_fma_f32 v[146:147], v[90:91], v[122:123], v[146:147]
    v_pk_fma_f32 v[148:149], v[92:93], v[124:125], v[148:149]
    v_pk_fma_f32 v[150:151], v[94:95], v[126:127], v[150:151]
    v_cvt_pk_bf16_f32 v132, v144, v145
    v_cvt_pk_bf16_f32 v133, v146, v147
    v_cvt_pk_bf16_f32 v134, v148, v149
    v_cvt_pk_bf16_f32 v135, v150, v151
    buffer_store_dwordx4 v[132:135], v12, s[60:63], s86 offen offset:64 sc1
L_end:
    s_endpgm
.if (L_end - L_pc) < 32768
.error "code smaller than the prefetched range"
.endif
.section .rodata,"a"
.p2align 6
.amdhsa_kernel recurrent_scan__linear_attn_block__dense_activation_mish__prompt_kernel
  .amdhsa_next_free_vgpr 512
  .amdhsa_next_free_sgpr 102
  .amdhsa_accum_offset 256
  .amdhsa_group_segment_fixed_size 0
  .amdhsa_kernarg_size 80
  .amdhsa_user_sgpr_count 2
  .amdhsa_user_sgpr_kernarg_segment_ptr 1
  .amdhsa_system_sgpr_workgroup_id_x 1
.end_amdhsa_kernel
```
